```python
import torch

def _softmax(x, axis=-1):
    return torch.softmax(x, dim=axis)
def _gelu(x):
    return torch.nn.functional.gelu(x, approximate="tanh")
def _silu(x):
    return torch.nn.functional.silu(x)
def _sigmoid(x):
    return torch.sigmoid(x)
def _layernorm(x, axis=-1, eps=1e-5):
    m = x.mean(dim=axis, keepdim=True)
    v = x.var(dim=axis, keepdim=True, unbiased=False)
    return (x - m) / torch.sqrt(v + eps)
def _scatter_add(tgt, idx, src, axis=0):
    return tgt.clone().index_add_(axis, idx, src)
def _segment_sum(src, seg, n):
    out = torch.zeros((n,) + src.shape[1:], dtype=src.dtype)
    return out.index_add_(0, seg, src)
def _pad(x, pw):
    flat = tuple(v for pair in reversed(pw) for v in pair)
    return torch.nn.functional.pad(x, flat)

kernel_name = 'concat_heads__gqa_block_cached__sliding_block_cached__decode'

def setup_inputs():

    _w = (lambda a: (lambda t: t.to(torch.bfloat16) if t.is_floating_point() else t)(torch.as_tensor(a)))
    def _A_setup():
        B, Sq, D = 4, 1, 512
        Hq, Hkv, Sk, Dh = 32, 8, 8192, 128
        assert Hq % Hkv == 0, (Hq, Hkv)
        return {
            "x": _w((lambda *s: torch.randn(*s, dtype=torch.bfloat16) * 0.8)(B, Sq, D)),
            "k_cache": _w((lambda *s: torch.randn(*s, dtype=torch.bfloat16) * 1.6)(B, Hkv, Sk, Dh)),
            "v_cache": _w((lambda *s: torch.randn(*s, dtype=torch.bfloat16) * 0.2)(B, Hkv, Sk, Dh)),
            "wq": _w((lambda *s: torch.randn(*s, dtype=torch.bfloat16) * 1.6)(D, Hq * Dh) * (D ** -0.5)),
            "wo": _w((lambda *s: torch.randn(*s, dtype=torch.bfloat16) * 0.2)(Hq * Dh, D) * ((Hq * Dh) ** -0.5)),
        }
    _A_in = _A_setup()

    def _B_setup():
        B, Sq, D = 4, 1, 512
        Hq, Hkv, Sk, Dh = 32, 8, 8192, 128
        assert Hq % Hkv == 0, (Hq, Hkv)
        return {
            "x": _w((lambda *s: torch.randn(*s, dtype=torch.bfloat16) * 0.8)(B, Sq, D)),
            "k_cache": _w((lambda *s: torch.randn(*s, dtype=torch.bfloat16) * 1.6)(B, Hkv, Sk, Dh)),
            "v_cache": _w((lambda *s: torch.randn(*s, dtype=torch.bfloat16) * 0.2)(B, Hkv, Sk, Dh)),
            "wq": _w((lambda *s: torch.randn(*s, dtype=torch.bfloat16) * 1.6)(D, Hq * Dh) * (D ** -0.5)),
            "wo": _w((lambda *s: torch.randn(*s, dtype=torch.bfloat16) * 0.2)(Hq * Dh, D) * ((Hq * Dh) ** -0.5)),
        }
    _B_in = _B_setup()

    return {
        "A_x": _A_in["x"],
        "A_k_cache": _A_in["k_cache"],
        "A_v_cache": _A_in["v_cache"],
        "A_wq": _A_in["wq"],
        "A_wo": _A_in["wo"],
        "B_x": _B_in["x"],
        "B_k_cache": _B_in["k_cache"],
        "B_v_cache": _B_in["v_cache"],
        "B_wq": _B_in["wq"],
        "B_wo": _B_in["wo"],
    }

def reference(A_x, A_k_cache, A_v_cache, A_wq, A_wo, B_x, B_k_cache, B_v_cache, B_wq, B_wo):
    def _A_ref(x, k_cache, v_cache, wq, wo):
        B, Sq, D = x.shape
        Hq, Dh = 32, 128
        Hkv = k_cache.shape[1]
        rep = Hq // Hkv
        q = (lambda x, *d: x.permute(*d))((x @ wq).reshape(B, Sq, Hq, Dh), 0, 2, 1, 3)
        k = (lambda x, n, axis: torch.repeat_interleave(x, n, dim=axis))(k_cache, rep, axis=1)
        v = (lambda x, n, axis: torch.repeat_interleave(x, n, dim=axis))(v_cache, rep, axis=1)
        scores = torch.einsum("bhqd,bhkd->bhqk", q, k) * (Dh ** -0.5)
        p = _softmax(scores, axis=-1)
        o = torch.einsum("bhqk,bhkd->bhqd", p, v)
        return (lambda x, *d: x.permute(*d))(o, 0, 2, 1, 3).reshape(B, Sq, Hq * Dh) @ wo

    def _B_ref(x, k_cache, v_cache, wq, wo):
        B, Sq, D = x.shape
        Hq, Dh = 32, 128
        Hkv, Sk = k_cache.shape[1], k_cache.shape[2]
        W = min(4096, max(256, Sk // 4))
        rep = Hq // Hkv
        q = (lambda x, *d: x.permute(*d))((x @ wq).reshape(B, Sq, Hq, Dh), 0, 2, 1, 3)
        k = (lambda x, n, axis: torch.repeat_interleave(x, n, dim=axis))(k_cache[:, :, Sk - W:, :], rep, axis=1)
        v = (lambda x, n, axis: torch.repeat_interleave(x, n, dim=axis))(v_cache[:, :, Sk - W:, :], rep, axis=1)
        scores = torch.einsum("bhqd,bhkd->bhqk", q, k) * (Dh ** -0.5)
        p = _softmax(scores, axis=-1)
        o = torch.einsum("bhqk,bhkd->bhqd", p, v)
        return (lambda x, *d: x.permute(*d))(o, 0, 2, 1, 3).reshape(B, Sq, Hq * Dh) @ wo

    a = _A_ref(A_x, A_k_cache, A_v_cache, A_wq, A_wo)
    b = _B_ref(B_x, B_k_cache, B_v_cache, B_wq, B_wo)
    return torch.concatenate([a, b], axis=-1)
```

```asm
; @launch grid=(256,1,1) block=(256,1,1) lds=50176
.amdgcn_target "amdgcn-amd-amdhsa--gfx950"
.text
.globl concat_heads__gqa_block_cached__sliding_block_cached__decode_kernel
.p2align 8
.type concat_heads__gqa_block_cached__sliding_block_cached__decode_kernel,@function
concat_heads__gqa_block_cached__sliding_block_cached__decode_kernel:
s_load_dwordx16 s[4:19], s[0:1], 0
s_load_dwordx8 s[20:27], s[0:1], 64
s_load_dwordx2 s[28:29], s[0:1], 96
s_cmp_ge_u32 s2, 256
s_cbranch_scc1 L_end
v_lshrrev_b32 v1, 6, v0
s_nop 0
v_readfirstlane_b32 s3, v1
v_and_b32 v1, 63, v0
s_getpc_b64 s[100:101]
v_lshlrev_b32 v43, 7, v0
v_min_u32 v43, L_code_end-concat_heads__gqa_block_cached__sliding_block_cached__decode_kernel-128, v43
global_load_dword v42, v43, s[100:101]
v_lshrrev_b32 v10, 4, v1
v_and_b32 v11, 15, v1
v_and_b32 v36, 1, v10
v_lshlrev_b32 v36, 1, v36
v_and_b32 v37, 7, v1
v_xor_b32 v36, v36, v37
v_lshlrev_b32 v36, 4, v36
v_lshrrev_b32 v37, 3, v1
v_lshl_add_u32 v44, v37, 13, v36
v_xor_b32 v45, 64, v44
v_lshlrev_b32 v3, 4, v1
s_lshr_b32 s77, s2, 3
s_and_b32 s30, s77, 1
s_lshl_b32 s30, s30, 21
s_lshl_b32 s31, s3, 19
s_add_u32 s30, s30, s31
s_bfe_u32 s31, s77, 0x30001
s_lshl_b32 s31, s31, 7
s_add_u32 s30, s30, s31
s_and_b32 s31, s2, 7
s_lshl_b32 s31, s31, 10
s_add_u32 s70, s30, s31
s_lshl_b32 s75, s3, 13
s_bfe_u32 s30, s2, 196612
s_lshl_b32 s31, s30, 16
s_add_u32 s70, s70, s31
s_lshl_b32 s31, s30, 10
s_add_u32 s75, s75, s31
s_and_b32 s30, s30, 1
s_lshl_b32 s30, s30, 6
v_xor_b32 v45, s30, v45
v_xor_b32 v47, s30, v44
s_mov_b32 s50, 0x400000
s_mov_b32 s51, 0x20000
s_mov_b32 s54, 0x1000
s_mov_b32 s55, 0x20000
s_mul_i32 s30, s3, 1088
s_add_u32 m0, s30, 32768
s_lshl_b32 s30, s3, 10
s_cmp_lt_u32 s2, 128
s_waitcnt lgkmcnt(0)
s_cselect_b32 s52, s4, s14
s_cselect_b32 s53, s5, s15
s_cselect_b32 s48, s10, s20
s_cselect_b32 s49, s11, s21
buffer_load_dwordx4 v3, s[52:55], s30 offen  lds
s_mov_b32 s98, s70
s_xor_b32 m0, s75, 0
s_xor_b32 s30, s98, 0
buffer_load_dwordx4 v47, s[48:51], s30 offen nt lds
s_load_dword s73, s[28:29], 0
s_xor_b32 m0, s75, 1024
s_xor_b32 s30, s98, 65536
buffer_load_dwordx4 v45, s[48:51], s30 offen nt lds
s_xor_b32 m0, s75, 2048
s_xor_b32 s30, s98, 131072
buffer_load_dwordx4 v47, s[48:51], s30 offen nt lds
s_xor_b32 m0, s75, 3072
s_xor_b32 s30, s98, 196608
buffer_load_dwordx4 v45, s[48:51], s30 offen nt lds
s_xor_b32 m0, s75, 4096
s_xor_b32 s30, s98, 262144
buffer_load_dwordx4 v47, s[48:51], s30 offen nt lds
s_xor_b32 m0, s75, 5120
s_xor_b32 s30, s98, 327680
buffer_load_dwordx4 v45, s[48:51], s30 offen nt lds
s_xor_b32 m0, s75, 6144
s_xor_b32 s30, s98, 393216
buffer_load_dwordx4 v47, s[48:51], s30 offen nt lds
s_xor_b32 m0, s75, 7168
s_xor_b32 s30, s98, 458752
buffer_load_dwordx4 v45, s[48:51], s30 offen nt lds
s_mov_b32 s32, s6
s_mov_b32 s33, s7
s_mov_b32 s34, 67108864
s_mov_b32 s35, 0x20000
s_mov_b32 s40, s16
s_mov_b32 s41, s17
s_mov_b32 s42, 67108864
s_mov_b32 s43, 0x20000
s_mov_b32 s44, s18
s_mov_b32 s45, s19
s_mov_b32 s46, 67108864
s_mov_b32 s47, 0x20000
s_mov_b32 s36, s8
s_mov_b32 s37, s9
s_mov_b32 s38, 67108864
s_mov_b32 s39, 0x20000
s_mov_b32 s60, s28
s_mov_b32 s61, s29
s_mov_b32 s62, 1572864
s_mov_b32 s63, 0x20000
s_mov_b32 s64, s24
s_mov_b32 s65, s25
s_mov_b32 s66, 8192
s_mov_b32 s67, 0x20000
s_mov_b32 s56, s12
s_mov_b32 s57, s13
s_mov_b32 s58, 4194304
s_mov_b32 s59, 0x20000
s_mov_b32 s100, s26
s_mov_b32 s101, s27
v_lshrrev_b32 v36, 2, v11
v_lshlrev_b32 v2, 8, v36
v_lshl_add_u32 v2, v10, 6, v2
v_and_b32 v36, 3, v1
v_lshl_add_u32 v2, v36, 4, v2
s_and_b32 s68, s2, 31
s_lshl_b32 s68, s68, 21
s_bfe_u32 s30, s2, 65541
s_lshl_b32 s30, s30, 15
s_add_u32 s68, s68, s30
s_bfe_u32 s30, s2, 131078
s_lshl_b32 s30, s30, 19
s_add_u32 s68, s68, s30
s_bfe_u32 s30, s3, 131072
s_lshl_b32 s30, s30, 12
s_add_u32 s68, s68, s30
s_bfe_u32 s30, s2, 65542
s_lshl_b32 s30, s30, 17
s_xor_b32 s68, s68, s30
s_bfe_u32 s30, s2, 65543
s_lshl_b32 s30, s30, 18
s_xor_b32 s68, s68, s30
s_and_b32 s69, s2, 31
s_lshl_b32 s69, s69, 21
s_bfe_u32 s30, s2, 196613
s_lshl_b32 s30, s30, 14
s_add_u32 s69, s69, s30
s_bfe_u32 s30, s3, 131072
s_lshl_b32 s30, s30, 12
s_add_u32 s69, s69, s30
s_add_u32 s69, s69, 1572864
s_mov_b32 s71, 1040356334
s_mov_b32 s72, 0xffffff00
s_mov_b32 s74, 400000
s_and_b32 s16, s2, 7
s_mov_b32 s20, 4286709633
s_getreg_b32 s9, hwreg(HW_REG_XCC_ID, 0, 3)
s_lshl_b32 s9, s9, 5
s_and_b32 s30, s2, 31
s_lshl_b32 s30, s30, 21
s_add_u32 s30, s30, 0x1fff80
s_lshl_b32 s31, s16, 19
v_mov_b32 v36, s31
s_mov_b64 exec, 1
buffer_load_dword v41, v3, s[40:43], s30 offen
buffer_load_dword v41, v3, s[44:47], s30 offen
buffer_load_dword v41, v3, s[36:39], s30 offen
buffer_load_dword v41, v3, s[56:59], s31 offen
global_load_dword v41, v36, s[22:23]
s_mov_b64 exec, -1
v_and_b32 v36, 1, v1
v_lshlrev_b32 v36, 4, v36
v_mov_b32 v37, 0xffff
v_lshlrev_b32 v36, v36, v37
v_and_b32 v37, 2, v1
v_cmp_eq_u32 vcc, 0, v37
s_nop 1
v_cndmask_b32 v4, 0, v36, vcc
v_cndmask_b32 v5, v36, 0, vcc
v_lshrrev_b32 v36, 2, v11
v_lshl_add_u32 v36, v10, 3, v36
v_lshlrev_b32 v46, 7, v36
v_and_b32 v36, 3, v11
v_lshl_add_u32 v46, v36, 3, v46
v_lshrrev_b32 v36, 3, v11
v_lshl_add_u32 v46, v36, 5, v46
v_and_b32 v36, 1, v10
v_lshl_add_u32 v46, v36, 6, v46
s_lshl_b32 s30, s3, 5
v_xor_b32 v36, s30, v46
v_and_b32 v37, 3, v11
v_mul_u32_u24 v37, 1088, v37
v_lshl_add_u32 v37, v10, 4, v37
s_and_b32 s30, s77, 1
s_lshl_b32 s30, s30, 9
v_add_u32 v37, s30, v37
v_lshlrev_b32 v38, 13, v11
v_lshl_add_u32 v38, v10, 4, v38
s_lshl_b32 s5, s16, 15
s_lshl_b32 s30, s3, 11
s_add_u32 s5, s5, s30
s_add_u32 s5, s5, 4096
s_and_b32 s30, s77, 1
s_lshl_b32 s30, s30, 10
s_lshr_b32 s31, s77, 1
s_lshl_b32 s31, s31, 6
s_add_u32 s30, s30, s31
s_add_u32 s7, s30, s5
s_and_b32 s30, s77, 3
s_lshl_b32 s30, s30, 13
s_add_u32 s5, s5, s30
v_and_b32 v39, 3, v1
v_lshrrev_b32 v40, 5, v1
v_lshlrev_b32 v40, 10, v40
v_lshl_add_u32 v40, v39, 3, v40
v_bfe_u32 v39, v1, 2, 1
v_lshl_add_u32 v40, v39, 9, v40
v_bfe_u32 v39, v1, 3, 2
v_lshl_add_u32 v40, v39, 6, v40
s_lshr_b32 s30, s3, 1
s_lshl_b32 s30, s30, 8
s_and_b32 s31, s3, 1
s_lshl_b32 s31, s31, 5
s_add_u32 s30, s30, s31
v_add_u32 v40, s30, v40
s_waitcnt lgkmcnt(0)
s_add_u32 s73, s73, 1
s_and_b32 s30, s73, 31
s_or_b32 s30, s30, s9
v_mov_b32 v6, s30
s_lshr_b32 s30, s73, 5
s_add_u32 s30, s30, s73
s_add_u32 s30, s30, 8
s_and_b32 s30, s30, 31
s_or_b32 s30, s30, s9
v_mov_b32 v7, s30
s_lshr_b32 s30, s73, 10
s_add_u32 s30, s30, s73
s_add_u32 s30, s30, 16
s_and_b32 s30, s30, 31
s_or_b32 s30, s30, s9
v_mov_b32 v8, s30
s_lshr_b32 s30, s73, 15
s_add_u32 s30, s30, s73
s_add_u32 s30, s30, 24
s_and_b32 s30, s30, 31
s_or_b32 s30, s30, s9
v_mov_b32 v9, s30
s_lshl_b32 s27, s16, 2
s_add_u32 s27, s27, s3
s_lshl_b32 s27, s27, 7
s_add_u32 s27, s27, 327680
s_lshl_b32 s25, s77, 2
s_add_u32 s25, s25, s27
s_lshl_b32 s30, s16, 7
s_add_u32 s30, s30, 343936
v_mov_b32 v188, s27
v_mov_b32 v191, s30
v_cmp_gt_u32 vcc, 32, v1
s_nop 1
v_cndmask_b32 v188, v191, v188, vcc
v_lshl_add_u32 v188, v1, 2, v188
s_and_b32 s31, s77, 28
s_add_u32 s30, s30, s31
s_add_u32 s30, s30, 128
s_lshr_b32 s31, s77, 2
s_xor_b32 s31, s31, s77
s_xor_b32 s26, s77, s3
s_or_b32 s31, s31, s26
s_and_b32 s31, s31, 3
s_cmp_eq_u32 s31, 0
s_cselect_b32 s26, 1, 0
s_cselect_b32 s30, s30, 2146435072
v_mov_b32 v191, s30
v_writelane_b32 v191, s25, 0
s_lshl_b32 s24, s73, 8
s_mov_b32 s27, 0
s_waitcnt vmcnt(9)
s_xor_b32 s70, s68, 0
buffer_load_dwordx4 v[64:67], v2, s[32:35], s70 offen offset:0 nt
s_waitcnt vmcnt(9)
buffer_load_dwordx4 v[68:71], v2, s[32:35], s70 offen offset:1024 nt
s_waitcnt vmcnt(9)
buffer_load_dwordx4 v[72:75], v2, s[32:35], s70 offen offset:2048 nt
s_waitcnt vmcnt(9)
buffer_load_dwordx4 v[76:79], v2, s[32:35], s70 offen offset:3072 nt
s_waitcnt vmcnt(9)
s_xor_b32 s70, s68, 16384
buffer_load_dwordx4 v[80:83], v2, s[32:35], s70 offen offset:0 nt
s_barrier
ds_read_b64_tr_b16 v[192:193], v36 offset:0
ds_read_b64_tr_b16 v[194:195], v36 offset:512
ds_read_b128 v[224:227], v37 offset:32768
ds_read_b64_tr_b16 v[196:197], v36 offset:4096
ds_read_b64_tr_b16 v[198:199], v36 offset:4608
ds_read_b128 v[228:231], v37 offset:32832
ds_read_b64_tr_b16 v[200:201], v36 offset:8192
ds_read_b64_tr_b16 v[202:203], v36 offset:8704
ds_read_b128 v[232:235], v37 offset:32896
ds_read_b64_tr_b16 v[204:205], v36 offset:12288
ds_read_b64_tr_b16 v[206:207], v36 offset:12800
ds_read_b128 v[236:239], v37 offset:32960
s_waitcnt vmcnt(4)
buffer_load_dwordx4 v[84:87], v2, s[32:35], s70 offen offset:1024 nt
s_waitcnt lgkmcnt(0)
ds_read_b64_tr_b16 v[208:209], v36 offset:16384
ds_read_b64_tr_b16 v[210:211], v36 offset:16896
ds_read_b128 v[240:243], v37 offset:33024
v_mfma_f32_16x16x32_bf16 v[20:23], v[192:195], v[224:227], 0
ds_read_b64_tr_b16 v[212:213], v36 offset:20480
ds_read_b64_tr_b16 v[214:215], v36 offset:20992
ds_read_b128 v[244:247], v37 offset:33088
v_mfma_f32_16x16x32_bf16 v[20:23], v[196:199], v[228:231], v[20:23]
ds_read_b64_tr_b16 v[216:217], v36 offset:24576
ds_read_b64_tr_b16 v[218:219], v36 offset:25088
ds_read_b128 v[248:251], v37 offset:33152
v_mfma_f32_16x16x32_bf16 v[20:23], v[200:203], v[232:235], v[20:23]
ds_read_b64_tr_b16 v[220:221], v36 offset:28672
ds_read_b64_tr_b16 v[222:223], v36 offset:29184
ds_read_b128 v[252:255], v37 offset:33216
v_mfma_f32_16x16x32_bf16 v[20:23], v[204:207], v[236:239], v[20:23]
s_waitcnt vmcnt(4)
buffer_load_dwordx4 v[88:91], v2, s[32:35], s70 offen offset:2048 nt
s_waitcnt lgkmcnt(0)
v_mfma_f32_16x16x32_bf16 v[20:23], v[208:211], v[240:243], v[20:23]
v_mfma_f32_16x16x32_bf16 v[20:23], v[212:215], v[244:247], v[20:23]
v_mfma_f32_16x16x32_bf16 v[20:23], v[216:219], v[248:251], v[20:23]
v_mfma_f32_16x16x32_bf16 v[20:23], v[220:223], v[252:255], v[20:23]
s_nop 7
v_and_or_b32 v20, v20, s72, v6
v_and_or_b32 v21, v21, s72, v7
v_and_or_b32 v22, v22, s72, v8
v_and_or_b32 v23, v23, s72, v9
s_mov_b32 exec_lo, 0x000f000f
s_mov_b32 exec_hi, 0x000f000f
buffer_store_dwordx4 v[20:23], v38, s[60:63], s7 offen sc1 nt
s_mov_b64 exec, -1
s_waitcnt vmcnt(5)
buffer_load_dwordx4 v[92:95], v2, s[32:35], s70 offen offset:3072 nt
s_add_u32 s30, s24, 0
v_mov_b32 v189, s30
s_mov_b32 exec_hi, 0xff
buffer_load_dword v190, v188, s[60:63], 0 offen nt
s_mov_b64 exec, 1
buffer_store_dword v189, v191, s[60:63], 0 offen
s_mov_b64 exec, -1
s_waitcnt vmcnt(7)
s_xor_b32 s70, s68, 65536
buffer_load_dwordx4 v[96:99], v2, s[32:35], s70 offen offset:0 nt
s_waitcnt vmcnt(7)
buffer_load_dwordx4 v[100:103], v2, s[32:35], s70 offen offset:1024 nt
s_waitcnt vmcnt(7)
buffer_load_dwordx4 v[104:107], v2, s[32:35], s70 offen offset:2048 nt
s_waitcnt vmcnt(7)
buffer_load_dwordx4 v[108:111], v2, s[32:35], s70 offen offset:3072 nt
s_barrier
s_waitcnt vmcnt(6)
s_xor_b32 s70, s68, 81920
buffer_load_dwordx4 v[112:115], v2, s[32:35], s70 offen offset:0 nt
s_waitcnt vmcnt(4)
buffer_load_dwordx4 v[116:119], v2, s[32:35], s70 offen offset:1024 nt
s_add_u32 s30, s24, 0
v_subrev_u32 v189, s30, v190
v_cmp_gt_u32 vcc, 64, v189
s_nop 0
s_bcnt1_i32_b32 s27, vcc_lo
s_add_u32 s27, s27, 12
s_cmp_ge_u32 s27, 34
s_cbranch_scc1 L_w14
s_waitcnt vmcnt(4)
L_w14:
buffer_load_dwordx4 v[120:123], v2, s[32:35], s70 offen offset:2048 nt
s_cmp_ge_u32 s27, 34
s_cbranch_scc1 L_w15
s_waitcnt vmcnt(4)
L_w15:
buffer_load_dwordx4 v[124:127], v2, s[32:35], s70 offen offset:3072 nt
s_cmp_ge_u32 s27, 34
s_cbranch_scc1 L_w16
s_waitcnt vmcnt(4)
L_w16:
s_xor_b32 s70, s68, 131072
buffer_load_dwordx4 v[128:131], v2, s[32:35], s70 offen offset:0 nt
s_waitcnt vmcnt(7)
s_cmp_ge_u32 s27, 34
s_cbranch_scc1 L_w17
s_waitcnt vmcnt(4)
L_w17:
buffer_load_dwordx4 v[132:135], v2, s[32:35], s70 offen offset:1024 nt
s_waitcnt vmcnt(7)
s_cmp_ge_u32 s27, 34
s_cbranch_scc1 L_w18
s_waitcnt vmcnt(4)
L_w18:
buffer_load_dwordx4 v[136:139], v2, s[32:35], s70 offen offset:2048 nt
s_waitcnt vmcnt(7)
s_cmp_ge_u32 s27, 34
s_cbranch_scc1 L_w19
s_waitcnt vmcnt(4)
L_w19:
buffer_load_dwordx4 v[140:143], v2, s[32:35], s70 offen offset:3072 nt
s_barrier
s_add_u32 s30, s24, 1
v_mov_b32 v189, s30
s_cmp_eq_u32 s26, 0
s_cbranch_scc1 L_ga1
s_mov_b32 s25, 1
s_atomic_add s25, s[100:101], 64 glc
L_ga1:
s_mov_b32 exec_hi, 0xff
buffer_load_dword v190, v188, s[60:63], 0 offen nt
s_mov_b64 exec, 1
buffer_store_dword v189, v191, s[60:63], 0 offen
s_mov_b64 exec, -1
s_waitcnt vmcnt(9)
s_cmp_ge_u32 s27, 34
s_cbranch_scc1 L_w20
s_waitcnt vmcnt(6)
L_w20:
s_xor_b32 s70, s68, 147456
buffer_load_dwordx4 v[144:147], v2, s[32:35], s70 offen offset:0 nt
s_waitcnt vmcnt(9)
s_cmp_ge_u32 s27, 34
s_cbranch_scc1 L_w21
s_waitcnt vmcnt(6)
L_w21:
buffer_load_dwordx4 v[148:151], v2, s[32:35], s70 offen offset:1024 nt
s_waitcnt vmcnt(9)
s_cmp_ge_u32 s27, 34
s_cbranch_scc1 L_w22
s_waitcnt vmcnt(6)
L_w22:
buffer_load_dwordx4 v[152:155], v2, s[32:35], s70 offen offset:2048 nt
s_waitcnt vmcnt(9)
s_cmp_ge_u32 s27, 34
s_cbranch_scc1 L_w23
s_waitcnt vmcnt(6)
L_w23:
buffer_load_dwordx4 v[156:159], v2, s[32:35], s70 offen offset:3072 nt
s_waitcnt vmcnt(9)
s_cmp_ge_u32 s27, 34
s_cbranch_scc1 L_w24
s_waitcnt vmcnt(6)
L_w24:
s_xor_b32 s70, s68, 196608
buffer_load_dwordx4 v[160:163], v2, s[32:35], s70 offen offset:0 nt
s_waitcnt vmcnt(9)
s_cmp_ge_u32 s27, 34
s_cbranch_scc1 L_w25
s_waitcnt vmcnt(4)
L_w25:
buffer_load_dwordx4 v[164:167], v2, s[32:35], s70 offen offset:1024 nt
s_cmp_ge_u32 s27, 34
s_cbranch_scc1 L_e1
s_add_u32 s30, s24, 1
v_subrev_u32 v189, s30, v190
v_cmp_gt_u32 vcc, 64, v189
s_nop 0
s_bcnt1_i32_b32 s27, vcc_lo
s_add_u32 s27, s27, 12
L_e1:
s_waitcnt vmcnt(9)
s_cmp_ge_u32 s27, 34
s_cbranch_scc1 L_w26
s_waitcnt vmcnt(4)
L_w26:
buffer_load_dwordx4 v[168:171], v2, s[32:35], s70 offen offset:2048 nt
s_waitcnt vmcnt(9)
s_cmp_ge_u32 s27, 34
s_cbranch_scc1 L_w27
s_waitcnt vmcnt(4)
L_w27:
buffer_load_dwordx4 v[172:175], v2, s[32:35], s70 offen offset:3072 nt
s_barrier
s_waitcnt vmcnt(7)
s_cmp_ge_u32 s27, 34
s_cbranch_scc1 L_w28
s_waitcnt vmcnt(4)
L_w28:
s_xor_b32 s70, s68, 212992
buffer_load_dwordx4 v[176:179], v2, s[32:35], s70 offen offset:0 nt
s_add_u32 s30, s24, 1
v_subrev_u32 v189, s30, v190
v_cmp_gt_u32 vcc, 64, v189
s_nop 0
s_bcnt1_i32_b32 s27, vcc_lo
s_add_u32 s27, s27, 12
s_waitcnt lgkmcnt(0)
s_bitcmp1_b32 s25, 5
s_cselect_b32 s30, 63, -1
s_add_u32 s30, s30, s24
v_mov_b32 v189, s30
s_mov_b64 exec, 2
buffer_store_dword v189, v191, s[60:63], 0 offen
s_mov_b64 exec, -1
s_waitcnt vmcnt(8)
s_cmp_ge_u32 s27, 34
s_cbranch_scc1 L_w29
s_waitcnt vmcnt(5)
L_w29:
buffer_load_dwordx4 v[180:183], v2, s[32:35], s70 offen offset:1024 nt
s_waitcnt vmcnt(8)
s_cmp_ge_u32 s27, 34
s_cbranch_scc1 L_w30
s_waitcnt vmcnt(5)
L_w30:
buffer_load_dwordx4 v[184:187], v2, s[32:35], s70 offen offset:2048 nt
s_waitcnt vmcnt(8)
s_cmp_ge_u32 s27, 34
s_cbranch_scc1 L_w31
s_waitcnt vmcnt(5)
L_w31:
buffer_load_dwordx4 v[192:195], v2, s[32:35], s70 offen offset:3072 nt
buffer_load_dwordx4 v[48:51], v3, s[60:63], s5 offen sc1 nt
buffer_load_dwordx4 v[52:55], v3, s[60:63], s5 offen offset:1024 sc1 nt
s_add_u32 s30, s24, 2
v_mov_b32 v189, s30
s_mov_b32 exec_hi, 0xff
buffer_load_dword v190, v188, s[60:63], 0 offen nt
s_mov_b64 exec, 1
buffer_store_dword v189, v191, s[60:63], 0 offen
s_mov_b64 exec, -1
s_waitcnt vmcnt(12)
s_cmp_ge_u32 s27, 34
s_cbranch_scc1 L_w32
s_waitcnt vmcnt(9)
L_w32:
s_xor_b32 s70, s68, 262144
buffer_load_dwordx4 v[196:199], v2, s[32:35], s70 offen offset:0 nt
s_waitcnt vmcnt(12)
s_cmp_ge_u32 s27, 34
s_cbranch_scc1 L_w33
s_waitcnt vmcnt(9)
L_w33:
buffer_load_dwordx4 v[200:203], v2, s[32:35], s70 offen offset:1024 nt
s_waitcnt vmcnt(12)
s_cmp_ge_u32 s27, 34
s_cbranch_scc1 L_w34
s_waitcnt vmcnt(8)
L_w34:
buffer_load_dwordx4 v[204:207], v2, s[32:35], s70 offen offset:2048 nt
s_waitcnt vmcnt(12)
s_cmp_ge_u32 s27, 34
s_cbranch_scc1 L_w35
s_waitcnt vmcnt(8)
L_w35:
buffer_load_dwordx4 v[208:211], v2, s[32:35], s70 offen offset:3072 nt
s_barrier
s_waitcnt vmcnt(12)
s_cmp_ge_u32 s27, 34
s_cbranch_scc1 L_w36
s_waitcnt vmcnt(8)
L_w36:
s_xor_b32 s70, s68, 278528
buffer_load_dwordx4 v[212:215], v2, s[32:35], s70 offen offset:0 nt
s_waitcnt vmcnt(11)
s_cmp_ge_u32 s27, 34
s_cbranch_scc1 L_w37
s_waitcnt vmcnt(4)
L_w37:
buffer_load_dwordx4 v[216:219], v2, s[32:35], s70 offen offset:1024 nt
s_cmp_ge_u32 s27, 34
s_cbranch_scc1 L_e2
s_add_u32 s30, s24, 2
v_subrev_u32 v189, s30, v190
v_cmp_gt_u32 vcc, 64, v189
s_nop 0
s_bcnt1_i32_b32 s27, vcc_lo
s_and_b32 s99, vcc_hi, 0xff
s_bcnt1_i32_b32 s99, s99
s_mul_i32 s99, s99, 3
s_add_u32 s27, s27, s99
L_e2:
s_waitcnt vmcnt(11)
s_cmp_ge_u32 s27, 34
s_cbranch_scc1 L_w38
s_waitcnt vmcnt(4)
L_w38:
buffer_load_dwordx4 v[220:223], v2, s[32:35], s70 offen offset:2048 nt
s_waitcnt vmcnt(11)
s_cmp_ge_u32 s27, 34
s_cbranch_scc1 L_w39
s_waitcnt vmcnt(4)
L_w39:
buffer_load_dwordx4 v[224:227], v2, s[32:35], s70 offen offset:3072 nt
s_waitcnt vmcnt(7)
s_cmp_ge_u32 s27, 34
s_cbranch_scc1 L_w40
s_waitcnt vmcnt(4)
L_w40:
s_xor_b32 s70, s68, 327680
buffer_load_dwordx4 v[228:231], v2, s[32:35], s70 offen offset:0 nt
L_chk_q:
v_xor_b32 v48, v6, v48
v_xor_b32 v49, v7, v49
v_xor_b32 v50, v8, v50
v_xor_b32 v51, v9, v51
v_xor_b32 v52, v6, v52
v_xor_b32 v53, v7, v53
v_xor_b32 v54, v8, v54
v_xor_b32 v55, v9, v55
v_or3_b32 v43, v48, v49, v50
v_or3_b32 v43, v43, v51, v52
v_or3_b32 v43, v43, v53, v54
v_or_b32 v43, v43, v55
v_cmp_ne_u32_sdwa vcc, v43, v0 src0_sel:BYTE_0 src1_sel:BYTE_3
s_mov_b32 s76, 0
s_cbranch_vccnz L_x_q
L_ok_q:
v_pk_add_f32 v[48:49], v[48:49], v[52:53]
v_pk_add_f32 v[50:51], v[50:51], v[54:55]
v_cvt_pk_bf16_f32 v48, v48, v49
v_cvt_pk_bf16_f32 v49, v50, v51
ds_write_b64 v40, v[48:49] offset:37120
s_add_u32 s30, s24, 2
v_subrev_u32 v189, s30, v190
v_cmp_gt_u32 vcc, 64, v189
s_nop 0
s_bcnt1_i32_b32 s27, vcc_lo
s_and_b32 s99, vcc_hi, 0xff
s_bcnt1_i32_b32 s99, s99
s_mul_i32 s99, s99, 3
s_add_u32 s27, s27, s99
s_waitcnt vmcnt(7)
s_cmp_ge_u32 s27, 34
s_cbranch_scc1 L_w41
s_waitcnt vmcnt(4)
L_w41:
buffer_load_dwordx4 v[232:235], v2, s[32:35], s70 offen offset:1024 nt
s_waitcnt lgkmcnt(0)
s_barrier
ds_read_b128 v[12:15], v3 offset:37120
ds_read_b128 v[16:19], v3 offset:38144
s_and_b32 s30, s73, 0xff
v_mov_b32 v6, s30
s_lshr_b32 s30, s73, 8
s_add_u32 s30, s30, s73
s_add_u32 s30, s30, 64
s_and_b32 s30, s30, 0xff
v_mov_b32 v7, s30
s_lshr_b32 s30, s73, 16
s_add_u32 s30, s30, s73
s_add_u32 s30, s30, 128
s_and_b32 s30, s30, 0xff
v_mov_b32 v8, s30
s_lshr_b32 s30, s73, 24
s_add_u32 s30, s30, s73
s_add_u32 s30, s30, 192
s_and_b32 s30, s30, 0xff
v_mov_b32 v9, s30
s_waitcnt lgkmcnt(0)
s_waitcnt vmcnt(7)
s_cmp_ge_u32 s27, 34
s_cbranch_scc1 L_w42
s_waitcnt vmcnt(4)
L_w42:
buffer_load_dwordx4 v[236:239], v2, s[32:35], s70 offen offset:2048 nt
v_mfma_f32_16x16x32_bf16 v[64:67], v[64:67], v[12:15], 0
v_mfma_f32_16x16x32_bf16 v[68:71], v[68:71], v[12:15], 0
v_mfma_f32_16x16x32_bf16 v[72:75], v[72:75], v[12:15], 0
v_mfma_f32_16x16x32_bf16 v[76:79], v[76:79], v[12:15], 0
s_nop 4
v_mov_b32_dpp v48, v64 quad_perm:[0,0,0,0] row_mask:0xf bank_mask:0xf
v_mov_b32_dpp v49, v68 quad_perm:[0,0,0,0] row_mask:0xf bank_mask:0xf
v_mov_b32_dpp v50, v72 quad_perm:[0,0,0,0] row_mask:0xf bank_mask:0xf
v_mov_b32_dpp v51, v76 quad_perm:[0,0,0,0] row_mask:0xf bank_mask:0xf
v_add_f32_dpp v48, v65, v48 quad_perm:[1,1,1,1] row_mask:0xf bank_mask:0xf
v_add_f32_dpp v49, v69, v49 quad_perm:[1,1,1,1] row_mask:0xf bank_mask:0xf
v_add_f32_dpp v50, v73, v50 quad_perm:[1,1,1,1] row_mask:0xf bank_mask:0xf
v_add_f32_dpp v51, v77, v51 quad_perm:[1,1,1,1] row_mask:0xf bank_mask:0xf
v_add_f32_dpp v48, v66, v48 quad_perm:[2,2,2,2] row_mask:0xf bank_mask:0xf
v_add_f32_dpp v49, v70, v49 quad_perm:[2,2,2,2] row_mask:0xf bank_mask:0xf
v_add_f32_dpp v50, v74, v50 quad_perm:[2,2,2,2] row_mask:0xf bank_mask:0xf
v_add_f32_dpp v51, v78, v51 quad_perm:[2,2,2,2] row_mask:0xf bank_mask:0xf
v_add_f32_dpp v48, v67, v48 quad_perm:[3,3,3,3] row_mask:0xf bank_mask:0xf
v_add_f32_dpp v49, v71, v49 quad_perm:[3,3,3,3] row_mask:0xf bank_mask:0xf
v_add_f32_dpp v50, v75, v50 quad_perm:[3,3,3,3] row_mask:0xf bank_mask:0xf
v_add_f32_dpp v51, v79, v51 quad_perm:[3,3,3,3] row_mask:0xf bank_mask:0xf
v_max_f32 v30, v48, v49
v_max3_f32 v30, v50, v51, v30
s_waitcnt vmcnt(7)
s_cmp_ge_u32 s27, 34
s_cbranch_scc1 L_w43
s_waitcnt vmcnt(4)
L_w43:
buffer_load_dwordx4 v[240:243], v2, s[32:35], s70 offen offset:3072 nt
v_mfma_f32_16x16x32_bf16 v[80:83], v[80:83], v[12:15], 0
v_mfma_f32_16x16x32_bf16 v[84:87], v[84:87], v[12:15], 0
v_mfma_f32_16x16x32_bf16 v[88:91], v[88:91], v[12:15], 0
v_mfma_f32_16x16x32_bf16 v[92:95], v[92:95], v[12:15], 0
s_nop 4
v_mov_b32_dpp v52, v80 quad_perm:[0,0,0,0] row_mask:0xf bank_mask:0xf
v_mov_b32_dpp v53, v84 quad_perm:[0,0,0,0] row_mask:0xf bank_mask:0xf
v_mov_b32_dpp v54, v88 quad_perm:[0,0,0,0] row_mask:0xf bank_mask:0xf
v_mov_b32_dpp v55, v92 quad_perm:[0,0,0,0] row_mask:0xf bank_mask:0xf
v_add_f32_dpp v52, v81, v52 quad_perm:[1,1,1,1] row_mask:0xf bank_mask:0xf
v_add_f32_dpp v53, v85, v53 quad_perm:[1,1,1,1] row_mask:0xf bank_mask:0xf
v_add_f32_dpp v54, v89, v54 quad_perm:[1,1,1,1] row_mask:0xf bank_mask:0xf
v_add_f32_dpp v55, v93, v55 quad_perm:[1,1,1,1] row_mask:0xf bank_mask:0xf
v_add_f32_dpp v52, v82, v52 quad_perm:[2,2,2,2] row_mask:0xf bank_mask:0xf
v_add_f32_dpp v53, v86, v53 quad_perm:[2,2,2,2] row_mask:0xf bank_mask:0xf
v_add_f32_dpp v54, v90, v54 quad_perm:[2,2,2,2] row_mask:0xf bank_mask:0xf
v_add_f32_dpp v55, v94, v55 quad_perm:[2,2,2,2] row_mask:0xf bank_mask:0xf
v_add_f32_dpp v52, v83, v52 quad_perm:[3,3,3,3] row_mask:0xf bank_mask:0xf
v_add_f32_dpp v53, v87, v53 quad_perm:[3,3,3,3] row_mask:0xf bank_mask:0xf
v_add_f32_dpp v54, v91, v54 quad_perm:[3,3,3,3] row_mask:0xf bank_mask:0xf
v_add_f32_dpp v55, v95, v55 quad_perm:[3,3,3,3] row_mask:0xf bank_mask:0xf
v_max3_f32 v30, v52, v53, v30
v_max3_f32 v30, v54, v55, v30
s_barrier
s_add_u32 s30, s24, 3
v_mov_b32 v189, s30
s_mov_b32 exec_hi, 0xff
buffer_load_dword v190, v188, s[60:63], 0 offen nt
s_mov_b64 exec, 1
buffer_store_dword v189, v191, s[60:63], 0 offen
s_mov_b64 exec, -1
s_waitcnt vmcnt(9)
s_cmp_ge_u32 s27, 34
s_cbranch_scc1 L_w44
s_waitcnt vmcnt(6)
L_w44:
s_xor_b32 s70, s68, 344064
buffer_load_dwordx4 v[244:247], v2, s[32:35], s70 offen offset:0 nt
v_mfma_f32_16x16x32_bf16 v[96:99], v[96:99], v[12:15], 0
v_mfma_f32_16x16x32_bf16 v[100:103], v[100:103], v[12:15], 0
v_mfma_f32_16x16x32_bf16 v[104:107], v[104:107], v[12:15], 0
v_mfma_f32_16x16x32_bf16 v[108:111], v[108:111], v[12:15], 0
s_nop 4
v_mov_b32_dpp v56, v96 quad_perm:[0,0,0,0] row_mask:0xf bank_mask:0xf
v_mov_b32_dpp v57, v100 quad_perm:[0,0,0,0] row_mask:0xf bank_mask:0xf
v_mov_b32_dpp v58, v104 quad_perm:[0,0,0,0] row_mask:0xf bank_mask:0xf
v_mov_b32_dpp v59, v108 quad_perm:[0,0,0,0] row_mask:0xf bank_mask:0xf
v_add_f32_dpp v56, v97, v56 quad_perm:[1,1,1,1] row_mask:0xf bank_mask:0xf
v_add_f32_dpp v57, v101, v57 quad_perm:[1,1,1,1] row_mask:0xf bank_mask:0xf
v_add_f32_dpp v58, v105, v58 quad_perm:[1,1,1,1] row_mask:0xf bank_mask:0xf
v_add_f32_dpp v59, v109, v59 quad_perm:[1,1,1,1] row_mask:0xf bank_mask:0xf
v_add_f32_dpp v56, v98, v56 quad_perm:[2,2,2,2] row_mask:0xf bank_mask:0xf
v_add_f32_dpp v57, v102, v57 quad_perm:[2,2,2,2] row_mask:0xf bank_mask:0xf
v_add_f32_dpp v58, v106, v58 quad_perm:[2,2,2,2] row_mask:0xf bank_mask:0xf
v_add_f32_dpp v59, v110, v59 quad_perm:[2,2,2,2] row_mask:0xf bank_mask:0xf
v_add_f32_dpp v56, v99, v56 quad_perm:[3,3,3,3] row_mask:0xf bank_mask:0xf
v_add_f32_dpp v57, v103, v57 quad_perm:[3,3,3,3] row_mask:0xf bank_mask:0xf
v_add_f32_dpp v58, v107, v58 quad_perm:[3,3,3,3] row_mask:0xf bank_mask:0xf
v_add_f32_dpp v59, v111, v59 quad_perm:[3,3,3,3] row_mask:0xf bank_mask:0xf
v_max3_f32 v30, v56, v57, v30
v_max3_f32 v30, v58, v59, v30
s_waitcnt vmcnt(9)
s_cmp_ge_u32 s27, 34
s_cbranch_scc1 L_w45
s_waitcnt vmcnt(6)
L_w45:
buffer_load_dwordx4 v[248:251], v2, s[32:35], s70 offen offset:1024 nt
v_mfma_f32_16x16x32_bf16 v[112:115], v[112:115], v[12:15], 0
v_mfma_f32_16x16x32_bf16 v[116:119], v[116:119], v[12:15], 0
v_mfma_f32_16x16x32_bf16 v[120:123], v[120:123], v[12:15], 0
v_mfma_f32_16x16x32_bf16 v[124:127], v[124:127], v[12:15], 0
s_nop 4
v_mov_b32_dpp v60, v112 quad_perm:[0,0,0,0] row_mask:0xf bank_mask:0xf
v_mov_b32_dpp v61, v116 quad_perm:[0,0,0,0] row_mask:0xf bank_mask:0xf
v_mov_b32_dpp v62, v120 quad_perm:[0,0,0,0] row_mask:0xf bank_mask:0xf
v_mov_b32_dpp v63, v124 quad_perm:[0,0,0,0] row_mask:0xf bank_mask:0xf
v_add_f32_dpp v60, v113, v60 quad_perm:[1,1,1,1] row_mask:0xf bank_mask:0xf
v_add_f32_dpp v61, v117, v61 quad_perm:[1,1,1,1] row_mask:0xf bank_mask:0xf
v_add_f32_dpp v62, v121, v62 quad_perm:[1,1,1,1] row_mask:0xf bank_mask:0xf
v_add_f32_dpp v63, v125, v63 quad_perm:[1,1,1,1] row_mask:0xf bank_mask:0xf
v_add_f32_dpp v60, v114, v60 quad_perm:[2,2,2,2] row_mask:0xf bank_mask:0xf
v_add_f32_dpp v61, v118, v61 quad_perm:[2,2,2,2] row_mask:0xf bank_mask:0xf
v_add_f32_dpp v62, v122, v62 quad_perm:[2,2,2,2] row_mask:0xf bank_mask:0xf
v_add_f32_dpp v63, v126, v63 quad_perm:[2,2,2,2] row_mask:0xf bank_mask:0xf
v_add_f32_dpp v60, v115, v60 quad_perm:[3,3,3,3] row_mask:0xf bank_mask:0xf
v_add_f32_dpp v61, v119, v61 quad_perm:[3,3,3,3] row_mask:0xf bank_mask:0xf
v_add_f32_dpp v62, v123, v62 quad_perm:[3,3,3,3] row_mask:0xf bank_mask:0xf
v_add_f32_dpp v63, v127, v63 quad_perm:[3,3,3,3] row_mask:0xf bank_mask:0xf
v_max3_f32 v30, v60, v61, v30
v_max3_f32 v30, v62, v63, v30
s_waitcnt vmcnt(9)
s_cmp_ge_u32 s27, 34
s_cbranch_scc1 L_w46
s_waitcnt vmcnt(6)
L_w46:
buffer_load_dwordx4 v[252:255], v2, s[32:35], s70 offen offset:2048 nt
v_mfma_f32_16x16x32_bf16 v[128:131], v[128:131], v[12:15], 0
v_mfma_f32_16x16x32_bf16 v[132:135], v[132:135], v[12:15], 0
v_mfma_f32_16x16x32_bf16 v[136:139], v[136:139], v[12:15], 0
v_mfma_f32_16x16x32_bf16 v[140:143], v[140:143], v[12:15], 0
s_nop 4
v_mov_b32_dpp v64, v128 quad_perm:[0,0,0,0] row_mask:0xf bank_mask:0xf
v_mov_b32_dpp v65, v132 quad_perm:[0,0,0,0] row_mask:0xf bank_mask:0xf
v_mov_b32_dpp v66, v136 quad_perm:[0,0,0,0] row_mask:0xf bank_mask:0xf
v_mov_b32_dpp v67, v140 quad_perm:[0,0,0,0] row_mask:0xf bank_mask:0xf
v_add_f32_dpp v64, v129, v64 quad_perm:[1,1,1,1] row_mask:0xf bank_mask:0xf
v_add_f32_dpp v65, v133, v65 quad_perm:[1,1,1,1] row_mask:0xf bank_mask:0xf
v_add_f32_dpp v66, v137, v66 quad_perm:[1,1,1,1] row_mask:0xf bank_mask:0xf
v_add_f32_dpp v67, v141, v67 quad_perm:[1,1,1,1] row_mask:0xf bank_mask:0xf
v_add_f32_dpp v64, v130, v64 quad_perm:[2,2,2,2] row_mask:0xf bank_mask:0xf
v_add_f32_dpp v65, v134, v65 quad_perm:[2,2,2,2] row_mask:0xf bank_mask:0xf
v_add_f32_dpp v66, v138, v66 quad_perm:[2,2,2,2] row_mask:0xf bank_mask:0xf
v_add_f32_dpp v67, v142, v67 quad_perm:[2,2,2,2] row_mask:0xf bank_mask:0xf
v_add_f32_dpp v64, v131, v64 quad_perm:[3,3,3,3] row_mask:0xf bank_mask:0xf
v_add_f32_dpp v65, v135, v65 quad_perm:[3,3,3,3] row_mask:0xf bank_mask:0xf
v_add_f32_dpp v66, v139, v66 quad_perm:[3,3,3,3] row_mask:0xf bank_mask:0xf
v_add_f32_dpp v67, v143, v67 quad_perm:[3,3,3,3] row_mask:0xf bank_mask:0xf
v_max3_f32 v30, v64, v65, v30
v_max3_f32 v30, v66, v67, v30
s_waitcnt vmcnt(9)
s_cmp_ge_u32 s27, 34
s_cbranch_scc1 L_w47
s_waitcnt vmcnt(6)
L_w47:
buffer_load_dwordx4 v[128:131], v2, s[32:35], s70 offen offset:3072 nt
v_mfma_f32_16x16x32_bf16 v[144:147], v[144:147], v[12:15], 0
v_mfma_f32_16x16x32_bf16 v[148:151], v[148:151], v[12:15], 0
v_mfma_f32_16x16x32_bf16 v[152:155], v[152:155], v[12:15], 0
v_mfma_f32_16x16x32_bf16 v[156:159], v[156:159], v[12:15], 0
s_nop 4
v_mov_b32_dpp v68, v144 quad_perm:[0,0,0,0] row_mask:0xf bank_mask:0xf
v_mov_b32_dpp v69, v148 quad_perm:[0,0,0,0] row_mask:0xf bank_mask:0xf
v_mov_b32_dpp v70, v152 quad_perm:[0,0,0,0] row_mask:0xf bank_mask:0xf
v_mov_b32_dpp v71, v156 quad_perm:[0,0,0,0] row_mask:0xf bank_mask:0xf
v_add_f32_dpp v68, v145, v68 quad_perm:[1,1,1,1] row_mask:0xf bank_mask:0xf
v_add_f32_dpp v69, v149, v69 quad_perm:[1,1,1,1] row_mask:0xf bank_mask:0xf
v_add_f32_dpp v70, v153, v70 quad_perm:[1,1,1,1] row_mask:0xf bank_mask:0xf
v_add_f32_dpp v71, v157, v71 quad_perm:[1,1,1,1] row_mask:0xf bank_mask:0xf
v_add_f32_dpp v68, v146, v68 quad_perm:[2,2,2,2] row_mask:0xf bank_mask:0xf
v_add_f32_dpp v69, v150, v69 quad_perm:[2,2,2,2] row_mask:0xf bank_mask:0xf
v_add_f32_dpp v70, v154, v70 quad_perm:[2,2,2,2] row_mask:0xf bank_mask:0xf
v_add_f32_dpp v71, v158, v71 quad_perm:[2,2,2,2] row_mask:0xf bank_mask:0xf
v_add_f32_dpp v68, v147, v68 quad_perm:[3,3,3,3] row_mask:0xf bank_mask:0xf
v_add_f32_dpp v69, v151, v69 quad_perm:[3,3,3,3] row_mask:0xf bank_mask:0xf
v_add_f32_dpp v70, v155, v70 quad_perm:[3,3,3,3] row_mask:0xf bank_mask:0xf
v_add_f32_dpp v71, v159, v71 quad_perm:[3,3,3,3] row_mask:0xf bank_mask:0xf
v_max3_f32 v30, v68, v69, v30
v_max3_f32 v30, v70, v71, v30
s_waitcnt vmcnt(9)
s_cmp_ge_u32 s27, 34
s_cbranch_scc1 L_w48
s_waitcnt vmcnt(6)
L_w48:
s_xor_b32 s70, s68, 393216
buffer_load_dwordx4 v[132:135], v2, s[32:35], s70 offen offset:0 nt
v_mfma_f32_16x16x32_bf16 v[160:163], v[160:163], v[12:15], 0
v_mfma_f32_16x16x32_bf16 v[164:167], v[164:167], v[12:15], 0
v_mfma_f32_16x16x32_bf16 v[168:171], v[168:171], v[12:15], 0
v_mfma_f32_16x16x32_bf16 v[172:175], v[172:175], v[12:15], 0
s_nop 4
v_mov_b32_dpp v72, v160 quad_perm:[0,0,0,0] row_mask:0xf bank_mask:0xf
v_mov_b32_dpp v73, v164 quad_perm:[0,0,0,0] row_mask:0xf bank_mask:0xf
v_mov_b32_dpp v74, v168 quad_perm:[0,0,0,0] row_mask:0xf bank_mask:0xf
v_mov_b32_dpp v75, v172 quad_perm:[0,0,0,0] row_mask:0xf bank_mask:0xf
v_add_f32_dpp v72, v161, v72 quad_perm:[1,1,1,1] row_mask:0xf bank_mask:0xf
v_add_f32_dpp v73, v165, v73 quad_perm:[1,1,1,1] row_mask:0xf bank_mask:0xf
v_add_f32_dpp v74, v169, v74 quad_perm:[1,1,1,1] row_mask:0xf bank_mask:0xf
v_add_f32_dpp v75, v173, v75 quad_perm:[1,1,1,1] row_mask:0xf bank_mask:0xf
v_add_f32_dpp v72, v162, v72 quad_perm:[2,2,2,2] row_mask:0xf bank_mask:0xf
v_add_f32_dpp v73, v166, v73 quad_perm:[2,2,2,2] row_mask:0xf bank_mask:0xf
v_add_f32_dpp v74, v170, v74 quad_perm:[2,2,2,2] row_mask:0xf bank_mask:0xf
v_add_f32_dpp v75, v174, v75 quad_perm:[2,2,2,2] row_mask:0xf bank_mask:0xf
v_add_f32_dpp v72, v163, v72 quad_perm:[3,3,3,3] row_mask:0xf bank_mask:0xf
v_add_f32_dpp v73, v167, v73 quad_perm:[3,3,3,3] row_mask:0xf bank_mask:0xf
v_add_f32_dpp v74, v171, v74 quad_perm:[3,3,3,3] row_mask:0xf bank_mask:0xf
v_add_f32_dpp v75, v175, v75 quad_perm:[3,3,3,3] row_mask:0xf bank_mask:0xf
v_max3_f32 v30, v72, v73, v30
v_max3_f32 v30, v74, v75, v30
s_waitcnt vmcnt(9)
s_cmp_ge_u32 s27, 34
s_cbranch_scc1 L_w49
s_waitcnt vmcnt(4)
L_w49:
buffer_load_dwordx4 v[136:139], v2, s[32:35], s70 offen offset:1024 nt
v_mfma_f32_16x16x32_bf16 v[176:179], v[176:179], v[12:15], 0
v_mfma_f32_16x16x32_bf16 v[180:183], v[180:183], v[12:15], 0
v_mfma_f32_16x16x32_bf16 v[184:187], v[184:187], v[12:15], 0
v_mfma_f32_16x16x32_bf16 v[192:195], v[192:195], v[12:15], 0
s_nop 4
v_mov_b32_dpp v76, v176 quad_perm:[0,0,0,0] row_mask:0xf bank_mask:0xf
v_mov_b32_dpp v77, v180 quad_perm:[0,0,0,0] row_mask:0xf bank_mask:0xf
v_mov_b32_dpp v78, v184 quad_perm:[0,0,0,0] row_mask:0xf bank_mask:0xf
v_mov_b32_dpp v79, v192 quad_perm:[0,0,0,0] row_mask:0xf bank_mask:0xf
v_add_f32_dpp v76, v177, v76 quad_perm:[1,1,1,1] row_mask:0xf bank_mask:0xf
v_add_f32_dpp v77, v181, v77 quad_perm:[1,1,1,1] row_mask:0xf bank_mask:0xf
v_add_f32_dpp v78, v185, v78 quad_perm:[1,1,1,1] row_mask:0xf bank_mask:0xf
v_add_f32_dpp v79, v193, v79 quad_perm:[1,1,1,1] row_mask:0xf bank_mask:0xf
v_add_f32_dpp v76, v178, v76 quad_perm:[2,2,2,2] row_mask:0xf bank_mask:0xf
v_add_f32_dpp v77, v182, v77 quad_perm:[2,2,2,2] row_mask:0xf bank_mask:0xf
v_add_f32_dpp v78, v186, v78 quad_perm:[2,2,2,2] row_mask:0xf bank_mask:0xf
v_add_f32_dpp v79, v194, v79 quad_perm:[2,2,2,2] row_mask:0xf bank_mask:0xf
v_add_f32_dpp v76, v179, v76 quad_perm:[3,3,3,3] row_mask:0xf bank_mask:0xf
v_add_f32_dpp v77, v183, v77 quad_perm:[3,3,3,3] row_mask:0xf bank_mask:0xf
v_add_f32_dpp v78, v187, v78 quad_perm:[3,3,3,3] row_mask:0xf bank_mask:0xf
v_add_f32_dpp v79, v195, v79 quad_perm:[3,3,3,3] row_mask:0xf bank_mask:0xf
v_max3_f32 v30, v76, v77, v30
v_max3_f32 v30, v78, v79, v30
s_cmp_ge_u32 s27, 34
s_cbranch_scc1 L_e3
s_add_u32 s30, s24, 3
v_subrev_u32 v189, s30, v190
v_cmp_gt_u32 vcc, 64, v189
s_nop 0
s_bcnt1_i32_b32 s27, vcc_lo
s_and_b32 s99, vcc_hi, 0xff
s_bcnt1_i32_b32 s99, s99
s_mul_i32 s99, s99, 3
s_add_u32 s27, s27, s99
L_e3:
s_waitcnt vmcnt(9)
s_cmp_ge_u32 s27, 34
s_cbranch_scc1 L_w50
s_waitcnt vmcnt(4)
L_w50:
buffer_load_dwordx4 v[140:143], v2, s[32:35], s70 offen offset:2048 nt
v_mfma_f32_16x16x32_bf16 v[196:199], v[196:199], v[12:15], 0
v_mfma_f32_16x16x32_bf16 v[200:203], v[200:203], v[12:15], 0
v_mfma_f32_16x16x32_bf16 v[204:207], v[204:207], v[12:15], 0
v_mfma_f32_16x16x32_bf16 v[208:211], v[208:211], v[12:15], 0
s_nop 4
v_mov_b32_dpp v80, v196 quad_perm:[0,0,0,0] row_mask:0xf bank_mask:0xf
v_mov_b32_dpp v81, v200 quad_perm:[0,0,0,0] row_mask:0xf bank_mask:0xf
v_mov_b32_dpp v82, v204 quad_perm:[0,0,0,0] row_mask:0xf bank_mask:0xf
v_mov_b32_dpp v83, v208 quad_perm:[0,0,0,0] row_mask:0xf bank_mask:0xf
v_add_f32_dpp v80, v197, v80 quad_perm:[1,1,1,1] row_mask:0xf bank_mask:0xf
v_add_f32_dpp v81, v201, v81 quad_perm:[1,1,1,1] row_mask:0xf bank_mask:0xf
v_add_f32_dpp v82, v205, v82 quad_perm:[1,1,1,1] row_mask:0xf bank_mask:0xf
v_add_f32_dpp v83, v209, v83 quad_perm:[1,1,1,1] row_mask:0xf bank_mask:0xf
v_add_f32_dpp v80, v198, v80 quad_perm:[2,2,2,2] row_mask:0xf bank_mask:0xf
v_add_f32_dpp v81, v202, v81 quad_perm:[2,2,2,2] row_mask:0xf bank_mask:0xf
v_add_f32_dpp v82, v206, v82 quad_perm:[2,2,2,2] row_mask:0xf bank_mask:0xf
v_add_f32_dpp v83, v210, v83 quad_perm:[2,2,2,2] row_mask:0xf bank_mask:0xf
v_add_f32_dpp v80, v199, v80 quad_perm:[3,3,3,3] row_mask:0xf bank_mask:0xf
v_add_f32_dpp v81, v203, v81 quad_perm:[3,3,3,3] row_mask:0xf bank_mask:0xf
v_add_f32_dpp v82, v207, v82 quad_perm:[3,3,3,3] row_mask:0xf bank_mask:0xf
v_add_f32_dpp v83, v211, v83 quad_perm:[3,3,3,3] row_mask:0xf bank_mask:0xf
v_max3_f32 v30, v80, v81, v30
v_max3_f32 v30, v82, v83, v30
s_waitcnt vmcnt(9)
s_cmp_ge_u32 s27, 34
s_cbranch_scc1 L_w51
s_waitcnt vmcnt(4)
L_w51:
buffer_load_dwordx4 v[144:147], v2, s[32:35], s70 offen offset:3072 nt
v_mfma_f32_16x16x32_bf16 v[212:215], v[212:215], v[12:15], 0
v_mfma_f32_16x16x32_bf16 v[216:219], v[216:219], v[12:15], 0
v_mfma_f32_16x16x32_bf16 v[220:223], v[220:223], v[12:15], 0
v_mfma_f32_16x16x32_bf16 v[224:227], v[224:227], v[12:15], 0
s_nop 4
v_mov_b32_dpp v84, v212 quad_perm:[0,0,0,0] row_mask:0xf bank_mask:0xf
v_mov_b32_dpp v85, v216 quad_perm:[0,0,0,0] row_mask:0xf bank_mask:0xf
v_mov_b32_dpp v86, v220 quad_perm:[0,0,0,0] row_mask:0xf bank_mask:0xf
v_mov_b32_dpp v87, v224 quad_perm:[0,0,0,0] row_mask:0xf bank_mask:0xf
v_add_f32_dpp v84, v213, v84 quad_perm:[1,1,1,1] row_mask:0xf bank_mask:0xf
v_add_f32_dpp v85, v217, v85 quad_perm:[1,1,1,1] row_mask:0xf bank_mask:0xf
v_add_f32_dpp v86, v221, v86 quad_perm:[1,1,1,1] row_mask:0xf bank_mask:0xf
v_add_f32_dpp v87, v225, v87 quad_perm:[1,1,1,1] row_mask:0xf bank_mask:0xf
v_add_f32_dpp v84, v214, v84 quad_perm:[2,2,2,2] row_mask:0xf bank_mask:0xf
v_add_f32_dpp v85, v218, v85 quad_perm:[2,2,2,2] row_mask:0xf bank_mask:0xf
v_add_f32_dpp v86, v222, v86 quad_perm:[2,2,2,2] row_mask:0xf bank_mask:0xf
v_add_f32_dpp v87, v226, v87 quad_perm:[2,2,2,2] row_mask:0xf bank_mask:0xf
v_add_f32_dpp v84, v215, v84 quad_perm:[3,3,3,3] row_mask:0xf bank_mask:0xf
v_add_f32_dpp v85, v219, v85 quad_perm:[3,3,3,3] row_mask:0xf bank_mask:0xf
v_add_f32_dpp v86, v223, v86 quad_perm:[3,3,3,3] row_mask:0xf bank_mask:0xf
v_add_f32_dpp v87, v227, v87 quad_perm:[3,3,3,3] row_mask:0xf bank_mask:0xf
v_max3_f32 v30, v84, v85, v30
v_max3_f32 v30, v86, v87, v30
s_barrier
s_waitcnt vmcnt(7)
s_cmp_ge_u32 s27, 34
s_cbranch_scc1 L_w52
s_waitcnt vmcnt(4)
L_w52:
s_xor_b32 s70, s68, 409600
buffer_load_dwordx4 v[148:151], v2, s[32:35], s70 offen offset:0 nt
v_mfma_f32_16x16x32_bf16 v[228:231], v[228:231], v[12:15], 0
v_mfma_f32_16x16x32_bf16 v[232:235], v[232:235], v[12:15], 0
v_mfma_f32_16x16x32_bf16 v[236:239], v[236:239], v[12:15], 0
v_mfma_f32_16x16x32_bf16 v[240:243], v[240:243], v[12:15], 0
s_nop 4
v_mov_b32_dpp v88, v228 quad_perm:[0,0,0,0] row_mask:0xf bank_mask:0xf
v_mov_b32_dpp v89, v232 quad_perm:[0,0,0,0] row_mask:0xf bank_mask:0xf
v_mov_b32_dpp v90, v236 quad_perm:[0,0,0,0] row_mask:0xf bank_mask:0xf
v_mov_b32_dpp v91, v240 quad_perm:[0,0,0,0] row_mask:0xf bank_mask:0xf
v_add_f32_dpp v88, v229, v88 quad_perm:[1,1,1,1] row_mask:0xf bank_mask:0xf
v_add_f32_dpp v89, v233, v89 quad_perm:[1,1,1,1] row_mask:0xf bank_mask:0xf
v_add_f32_dpp v90, v237, v90 quad_perm:[1,1,1,1] row_mask:0xf bank_mask:0xf
v_add_f32_dpp v91, v241, v91 quad_perm:[1,1,1,1] row_mask:0xf bank_mask:0xf
v_add_f32_dpp v88, v230, v88 quad_perm:[2,2,2,2] row_mask:0xf bank_mask:0xf
v_add_f32_dpp v89, v234, v89 quad_perm:[2,2,2,2] row_mask:0xf bank_mask:0xf
v_add_f32_dpp v90, v238, v90 quad_perm:[2,2,2,2] row_mask:0xf bank_mask:0xf
v_add_f32_dpp v91, v242, v91 quad_perm:[2,2,2,2] row_mask:0xf bank_mask:0xf
v_add_f32_dpp v88, v231, v88 quad_perm:[3,3,3,3] row_mask:0xf bank_mask:0xf
v_add_f32_dpp v89, v235, v89 quad_perm:[3,3,3,3] row_mask:0xf bank_mask:0xf
v_add_f32_dpp v90, v239, v90 quad_perm:[3,3,3,3] row_mask:0xf bank_mask:0xf
v_add_f32_dpp v91, v243, v91 quad_perm:[3,3,3,3] row_mask:0xf bank_mask:0xf
v_max3_f32 v30, v88, v89, v30
v_max3_f32 v30, v90, v91, v30
s_add_u32 s30, s24, 3
v_subrev_u32 v189, s30, v190
v_cmp_gt_u32 vcc, 64, v189
s_nop 0
s_bcnt1_i32_b32 s27, vcc_lo
s_and_b32 s99, vcc_hi, 0xff
s_bcnt1_i32_b32 s99, s99
s_mul_i32 s99, s99, 3
s_add_u32 s27, s27, s99
s_waitcnt vmcnt(7)
s_cmp_ge_u32 s27, 34
s_cbranch_scc1 L_w53
s_waitcnt vmcnt(4)
L_w53:
buffer_load_dwordx4 v[152:155], v2, s[32:35], s70 offen offset:1024 nt
s_waitcnt vmcnt(7)
s_cmp_ge_u32 s27, 34
s_cbranch_scc1 L_w54
s_waitcnt vmcnt(4)
L_w54:
buffer_load_dwordx4 v[156:159], v2, s[32:35], s70 offen offset:2048 nt
s_waitcnt vmcnt(7)
s_cmp_ge_u32 s27, 34
s_cbranch_scc1 L_w55
s_waitcnt vmcnt(4)
L_w55:
buffer_load_dwordx4 v[160:163], v2, s[32:35], s70 offen offset:3072 nt
v_mfma_f32_16x16x32_bf16 v[244:247], v[244:247], v[12:15], 0
v_mfma_f32_16x16x32_bf16 v[248:251], v[248:251], v[12:15], 0
v_mfma_f32_16x16x32_bf16 v[252:255], v[252:255], v[12:15], 0
v_mfma_f32_16x16x32_bf16 v[128:131], v[128:131], v[12:15], 0
s_nop 4
v_mov_b32_dpp v92, v244 quad_perm:[0,0,0,0] row_mask:0xf bank_mask:0xf
v_mov_b32_dpp v93, v248 quad_perm:[0,0,0,0] row_mask:0xf bank_mask:0xf
v_mov_b32_dpp v94, v252 quad_perm:[0,0,0,0] row_mask:0xf bank_mask:0xf
v_mov_b32_dpp v95, v128 quad_perm:[0,0,0,0] row_mask:0xf bank_mask:0xf
v_add_f32_dpp v92, v245, v92 quad_perm:[1,1,1,1] row_mask:0xf bank_mask:0xf
v_add_f32_dpp v93, v249, v93 quad_perm:[1,1,1,1] row_mask:0xf bank_mask:0xf
v_add_f32_dpp v94, v253, v94 quad_perm:[1,1,1,1] row_mask:0xf bank_mask:0xf
v_add_f32_dpp v95, v129, v95 quad_perm:[1,1,1,1] row_mask:0xf bank_mask:0xf
v_add_f32_dpp v92, v246, v92 quad_perm:[2,2,2,2] row_mask:0xf bank_mask:0xf
v_add_f32_dpp v93, v250, v93 quad_perm:[2,2,2,2] row_mask:0xf bank_mask:0xf
v_add_f32_dpp v94, v254, v94 quad_perm:[2,2,2,2] row_mask:0xf bank_mask:0xf
v_add_f32_dpp v95, v130, v95 quad_perm:[2,2,2,2] row_mask:0xf bank_mask:0xf
v_add_f32_dpp v92, v247, v92 quad_perm:[3,3,3,3] row_mask:0xf bank_mask:0xf
v_add_f32_dpp v93, v251, v93 quad_perm:[3,3,3,3] row_mask:0xf bank_mask:0xf
v_add_f32_dpp v94, v255, v94 quad_perm:[3,3,3,3] row_mask:0xf bank_mask:0xf
v_add_f32_dpp v95, v131, v95 quad_perm:[3,3,3,3] row_mask:0xf bank_mask:0xf
v_max3_f32 v30, v92, v93, v30
v_max3_f32 v30, v94, v95, v30
s_add_u32 s30, s24, 4
v_mov_b32 v189, s30
s_cmp_eq_u32 s26, 0
s_cbranch_scc1 L_ga4
s_mov_b32 s25, 1
s_atomic_add s25, s[100:101], 4 glc
L_ga4:
s_mov_b32 exec_hi, 0xff
buffer_load_dword v190, v188, s[60:63], 0 offen nt
s_mov_b64 exec, 1
buffer_store_dword v189, v191, s[60:63], 0 offen
s_mov_b64 exec, -1
s_waitcnt vmcnt(9)
s_cmp_ge_u32 s27, 34
s_cbranch_scc1 L_w56
s_waitcnt vmcnt(6)
L_w56:
s_xor_b32 s70, s68, 458752
buffer_load_dwordx4 v[128:131], v2, s[32:35], s70 offen offset:0 nt
s_waitcnt vmcnt(9)
s_cmp_ge_u32 s27, 34
s_cbranch_scc1 L_w57
s_waitcnt vmcnt(6)
L_w57:
buffer_load_dwordx4 v[164:167], v2, s[32:35], s70 offen offset:1024 nt
s_waitcnt vmcnt(9)
s_cmp_ge_u32 s27, 34
s_cbranch_scc1 L_w58
s_waitcnt vmcnt(6)
L_w58:
buffer_load_dwordx4 v[168:171], v2, s[32:35], s70 offen offset:2048 nt
s_waitcnt vmcnt(9)
s_cmp_ge_u32 s27, 34
s_cbranch_scc1 L_w59
s_waitcnt vmcnt(6)
L_w59:
buffer_load_dwordx4 v[172:175], v2, s[32:35], s70 offen offset:3072 nt
v_mfma_f32_16x16x32_bf16 v[132:135], v[132:135], v[12:15], 0
v_mfma_f32_16x16x32_bf16 v[136:139], v[136:139], v[12:15], 0
v_mfma_f32_16x16x32_bf16 v[140:143], v[140:143], v[12:15], 0
v_mfma_f32_16x16x32_bf16 v[144:147], v[144:147], v[12:15], 0
s_nop 4
v_mov_b32_dpp v96, v132 quad_perm:[0,0,0,0] row_mask:0xf bank_mask:0xf
v_mov_b32_dpp v97, v136 quad_perm:[0,0,0,0] row_mask:0xf bank_mask:0xf
v_mov_b32_dpp v98, v140 quad_perm:[0,0,0,0] row_mask:0xf bank_mask:0xf
v_mov_b32_dpp v99, v144 quad_perm:[0,0,0,0] row_mask:0xf bank_mask:0xf
v_add_f32_dpp v96, v133, v96 quad_perm:[1,1,1,1] row_mask:0xf bank_mask:0xf
v_add_f32_dpp v97, v137, v97 quad_perm:[1,1,1,1] row_mask:0xf bank_mask:0xf
v_add_f32_dpp v98, v141, v98 quad_perm:[1,1,1,1] row_mask:0xf bank_mask:0xf
v_add_f32_dpp v99, v145, v99 quad_perm:[1,1,1,1] row_mask:0xf bank_mask:0xf
v_add_f32_dpp v96, v134, v96 quad_perm:[2,2,2,2] row_mask:0xf bank_mask:0xf
v_add_f32_dpp v97, v138, v97 quad_perm:[2,2,2,2] row_mask:0xf bank_mask:0xf
v_add_f32_dpp v98, v142, v98 quad_perm:[2,2,2,2] row_mask:0xf bank_mask:0xf
v_add_f32_dpp v99, v146, v99 quad_perm:[2,2,2,2] row_mask:0xf bank_mask:0xf
v_add_f32_dpp v96, v135, v96 quad_perm:[3,3,3,3] row_mask:0xf bank_mask:0xf
v_add_f32_dpp v97, v139, v97 quad_perm:[3,3,3,3] row_mask:0xf bank_mask:0xf
v_add_f32_dpp v98, v143, v98 quad_perm:[3,3,3,3] row_mask:0xf bank_mask:0xf
v_add_f32_dpp v99, v147, v99 quad_perm:[3,3,3,3] row_mask:0xf bank_mask:0xf
v_max3_f32 v30, v96, v97, v30
v_max3_f32 v30, v98, v99, v30
s_barrier
s_waitcnt vmcnt(9)
s_cmp_ge_u32 s27, 34
s_cbranch_scc1 L_w60
s_waitcnt vmcnt(6)
L_w60:
s_xor_b32 s70, s68, 475136
buffer_load_dwordx4 v[132:135], v2, s[32:35], s70 offen offset:0 nt
s_waitcnt vmcnt(9)
s_cmp_ge_u32 s27, 34
s_cbranch_scc1 L_w61
s_waitcnt vmcnt(4)
L_w61:
buffer_load_dwordx4 v[136:139], v2, s[32:35], s70 offen offset:1024 nt
s_cmp_ge_u32 s27, 34
s_cbranch_scc1 L_e4
s_add_u32 s30, s24, 4
v_subrev_u32 v189, s30, v190
v_cmp_gt_u32 vcc, 64, v189
s_nop 0
s_bcnt1_i32_b32 s27, vcc_lo
s_and_b32 s99, vcc_hi, 0xff
s_bcnt1_i32_b32 s99, s99
s_mul_i32 s99, s99, 3
s_add_u32 s27, s27, s99
L_e4:
s_waitcnt vmcnt(9)
s_cmp_ge_u32 s27, 34
s_cbranch_scc1 L_w62
s_waitcnt vmcnt(4)
L_w62:
buffer_load_dwordx4 v[140:143], v2, s[32:35], s70 offen offset:2048 nt
s_waitcnt vmcnt(9)
s_cmp_ge_u32 s27, 34
s_cbranch_scc1 L_w63
s_waitcnt vmcnt(4)
L_w63:
buffer_load_dwordx4 v[144:147], v2, s[32:35], s70 offen offset:3072 nt
v_mfma_f32_16x16x32_bf16 v[148:151], v[148:151], v[12:15], 0
v_mfma_f32_16x16x32_bf16 v[152:155], v[152:155], v[12:15], 0
v_mfma_f32_16x16x32_bf16 v[156:159], v[156:159], v[12:15], 0
v_mfma_f32_16x16x32_bf16 v[160:163], v[160:163], v[12:15], 0
s_nop 4
v_mov_b32_dpp v100, v148 quad_perm:[0,0,0,0] row_mask:0xf bank_mask:0xf
v_mov_b32_dpp v101, v152 quad_perm:[0,0,0,0] row_mask:0xf bank_mask:0xf
v_mov_b32_dpp v102, v156 quad_perm:[0,0,0,0] row_mask:0xf bank_mask:0xf
v_mov_b32_dpp v103, v160 quad_perm:[0,0,0,0] row_mask:0xf bank_mask:0xf
v_add_f32_dpp v100, v149, v100 quad_perm:[1,1,1,1] row_mask:0xf bank_mask:0xf
v_add_f32_dpp v101, v153, v101 quad_perm:[1,1,1,1] row_mask:0xf bank_mask:0xf
v_add_f32_dpp v102, v157, v102 quad_perm:[1,1,1,1] row_mask:0xf bank_mask:0xf
v_add_f32_dpp v103, v161, v103 quad_perm:[1,1,1,1] row_mask:0xf bank_mask:0xf
v_add_f32_dpp v100, v150, v100 quad_perm:[2,2,2,2] row_mask:0xf bank_mask:0xf
v_add_f32_dpp v101, v154, v101 quad_perm:[2,2,2,2] row_mask:0xf bank_mask:0xf
v_add_f32_dpp v102, v158, v102 quad_perm:[2,2,2,2] row_mask:0xf bank_mask:0xf
v_add_f32_dpp v103, v162, v103 quad_perm:[2,2,2,2] row_mask:0xf bank_mask:0xf
v_add_f32_dpp v100, v151, v100 quad_perm:[3,3,3,3] row_mask:0xf bank_mask:0xf
v_add_f32_dpp v101, v155, v101 quad_perm:[3,3,3,3] row_mask:0xf bank_mask:0xf
v_add_f32_dpp v102, v159, v102 quad_perm:[3,3,3,3] row_mask:0xf bank_mask:0xf
v_add_f32_dpp v103, v163, v103 quad_perm:[3,3,3,3] row_mask:0xf bank_mask:0xf
v_max3_f32 v30, v100, v101, v30
v_max3_f32 v30, v102, v103, v30
s_waitcnt vmcnt(7)
s_cmp_ge_u32 s27, 34
s_cbranch_scc1 L_w64
s_waitcnt vmcnt(4)
L_w64:
s_xor_b32 s70, s69, 0
buffer_load_dwordx4 v[148:151], v2, s[40:43], s70 offen offset:0 nt
s_add_u32 s30, s24, 4
v_subrev_u32 v189, s30, v190
v_cmp_gt_u32 vcc, 64, v189
s_nop 0
s_bcnt1_i32_b32 s27, vcc_lo
s_and_b32 s99, vcc_hi, 0xff
s_bcnt1_i32_b32 s99, s99
s_mul_i32 s99, s99, 3
s_add_u32 s27, s27, s99
s_waitcnt lgkmcnt(0)
s_bitcmp1_b32 s25, 5
s_cselect_b32 s30, 63, -1
s_add_u32 s30, s30, s24
v_mov_b32 v189, s30
s_mov_b64 exec, 2
buffer_store_dword v189, v191, s[60:63], 0 offen
s_mov_b64 exec, -1
s_waitcnt vmcnt(8)
s_cmp_ge_u32 s27, 34
s_cbranch_scc1 L_w65
s_waitcnt vmcnt(5)
L_w65:
buffer_load_dwordx4 v[152:155], v2, s[40:43], s70 offen offset:1024 nt
s_waitcnt vmcnt(8)
s_cmp_ge_u32 s27, 34
s_cbranch_scc1 L_w66
s_waitcnt vmcnt(5)
L_w66:
buffer_load_dwordx4 v[156:159], v2, s[40:43], s70 offen offset:2048 nt
s_waitcnt vmcnt(8)
s_cmp_ge_u32 s27, 34
s_cbranch_scc1 L_w67
s_waitcnt vmcnt(5)
L_w67:
buffer_load_dwordx4 v[160:163], v2, s[40:43], s70 offen offset:3072 nt
v_mfma_f32_16x16x32_bf16 v[128:131], v[128:131], v[12:15], 0
v_mfma_f32_16x16x32_bf16 v[164:167], v[164:167], v[12:15], 0
v_mfma_f32_16x16x32_bf16 v[168:171], v[168:171], v[12:15], 0
v_mfma_f32_16x16x32_bf16 v[172:175], v[172:175], v[12:15], 0
s_nop 4
v_mov_b32_dpp v104, v128 quad_perm:[0,0,0,0] row_mask:0xf bank_mask:0xf
v_mov_b32_dpp v105, v164 quad_perm:[0,0,0,0] row_mask:0xf bank_mask:0xf
v_mov_b32_dpp v106, v168 quad_perm:[0,0,0,0] row_mask:0xf bank_mask:0xf
v_mov_b32_dpp v107, v172 quad_perm:[0,0,0,0] row_mask:0xf bank_mask:0xf
v_add_f32_dpp v104, v129, v104 quad_perm:[1,1,1,1] row_mask:0xf bank_mask:0xf
v_add_f32_dpp v105, v165, v105 quad_perm:[1,1,1,1] row_mask:0xf bank_mask:0xf
v_add_f32_dpp v106, v169, v106 quad_perm:[1,1,1,1] row_mask:0xf bank_mask:0xf
v_add_f32_dpp v107, v173, v107 quad_perm:[1,1,1,1] row_mask:0xf bank_mask:0xf
v_add_f32_dpp v104, v130, v104 quad_perm:[2,2,2,2] row_mask:0xf bank_mask:0xf
v_add_f32_dpp v105, v166, v105 quad_perm:[2,2,2,2] row_mask:0xf bank_mask:0xf
v_add_f32_dpp v106, v170, v106 quad_perm:[2,2,2,2] row_mask:0xf bank_mask:0xf
v_add_f32_dpp v107, v174, v107 quad_perm:[2,2,2,2] row_mask:0xf bank_mask:0xf
v_add_f32_dpp v104, v131, v104 quad_perm:[3,3,3,3] row_mask:0xf bank_mask:0xf
v_add_f32_dpp v105, v167, v105 quad_perm:[3,3,3,3] row_mask:0xf bank_mask:0xf
v_add_f32_dpp v106, v171, v106 quad_perm:[3,3,3,3] row_mask:0xf bank_mask:0xf
v_add_f32_dpp v107, v175, v107 quad_perm:[3,3,3,3] row_mask:0xf bank_mask:0xf
v_max3_f32 v30, v104, v105, v30
v_max3_f32 v30, v106, v107, v30
s_barrier
s_add_u32 s30, s24, 5
v_mov_b32 v189, s30
s_mov_b32 exec_hi, 0xff
buffer_load_dword v190, v188, s[60:63], 0 offen nt
s_mov_b64 exec, 1
buffer_store_dword v189, v191, s[60:63], 0 offen
s_mov_b64 exec, -1
s_waitcnt vmcnt(10)
s_cmp_ge_u32 s27, 34
s_cbranch_scc1 L_w68
s_waitcnt vmcnt(7)
L_w68:
s_xor_b32 s70, s69, 131072
buffer_load_dwordx4 v[128:131], v2, s[40:43], s70 offen offset:0 nt
s_waitcnt vmcnt(10)
s_cmp_ge_u32 s27, 34
s_cbranch_scc1 L_w69
s_waitcnt vmcnt(7)
L_w69:
buffer_load_dwordx4 v[164:167], v2, s[40:43], s70 offen offset:1024 nt
s_waitcnt vmcnt(10)
s_cmp_ge_u32 s27, 34
s_cbranch_scc1 L_w70
s_waitcnt vmcnt(6)
L_w70:
buffer_load_dwordx4 v[168:171], v2, s[40:43], s70 offen offset:2048 nt
s_waitcnt vmcnt(10)
s_cmp_ge_u32 s27, 34
s_cbranch_scc1 L_w71
s_waitcnt vmcnt(6)
L_w71:
buffer_load_dwordx4 v[172:175], v2, s[40:43], s70 offen offset:3072 nt
v_mfma_f32_16x16x32_bf16 v[132:135], v[132:135], v[12:15], 0
v_mfma_f32_16x16x32_bf16 v[136:139], v[136:139], v[12:15], 0
v_mfma_f32_16x16x32_bf16 v[140:143], v[140:143], v[12:15], 0
v_mfma_f32_16x16x32_bf16 v[144:147], v[144:147], v[12:15], 0
s_nop 4
v_mov_b32_dpp v108, v132 quad_perm:[0,0,0,0] row_mask:0xf bank_mask:0xf
v_mov_b32_dpp v109, v136 quad_perm:[0,0,0,0] row_mask:0xf bank_mask:0xf
v_mov_b32_dpp v110, v140 quad_perm:[0,0,0,0] row_mask:0xf bank_mask:0xf
v_mov_b32_dpp v111, v144 quad_perm:[0,0,0,0] row_mask:0xf bank_mask:0xf
v_add_f32_dpp v108, v133, v108 quad_perm:[1,1,1,1] row_mask:0xf bank_mask:0xf
v_add_f32_dpp v109, v137, v109 quad_perm:[1,1,1,1] row_mask:0xf bank_mask:0xf
v_add_f32_dpp v110, v141, v110 quad_perm:[1,1,1,1] row_mask:0xf bank_mask:0xf
v_add_f32_dpp v111, v145, v111 quad_perm:[1,1,1,1] row_mask:0xf bank_mask:0xf
v_add_f32_dpp v108, v134, v108 quad_perm:[2,2,2,2] row_mask:0xf bank_mask:0xf
v_add_f32_dpp v109, v138, v109 quad_perm:[2,2,2,2] row_mask:0xf bank_mask:0xf
v_add_f32_dpp v110, v142, v110 quad_perm:[2,2,2,2] row_mask:0xf bank_mask:0xf
v_add_f32_dpp v111, v146, v111 quad_perm:[2,2,2,2] row_mask:0xf bank_mask:0xf
v_add_f32_dpp v108, v135, v108 quad_perm:[3,3,3,3] row_mask:0xf bank_mask:0xf
v_add_f32_dpp v109, v139, v109 quad_perm:[3,3,3,3] row_mask:0xf bank_mask:0xf
v_add_f32_dpp v110, v143, v110 quad_perm:[3,3,3,3] row_mask:0xf bank_mask:0xf
v_add_f32_dpp v111, v147, v111 quad_perm:[3,3,3,3] row_mask:0xf bank_mask:0xf
v_max3_f32 v30, v108, v109, v30
v_max3_f32 v30, v110, v111, v30
s_waitcnt vmcnt(10)
s_cmp_ge_u32 s27, 34
s_cbranch_scc1 L_w72
s_waitcnt vmcnt(6)
L_w72:
s_xor_b32 s70, s69, 262144
buffer_load_dwordx4 v[132:135], v2, s[40:43], s70 offen offset:0 nt
s_waitcnt vmcnt(9)
s_cmp_ge_u32 s27, 34
s_cbranch_scc1 L_w73
s_waitcnt vmcnt(4)
L_w73:
buffer_load_dwordx4 v[136:139], v2, s[40:43], s70 offen offset:1024 nt
s_cmp_ge_u32 s27, 34
s_cbranch_scc1 L_e5
s_add_u32 s30, s24, 5
v_subrev_u32 v189, s30, v190
v_cmp_gt_u32 vcc, 64, v189
s_nop 0
s_bcnt1_i32_b32 s27, vcc_lo
s_and_b32 s99, vcc_hi, 0xff
s_bcnt1_i32_b32 s99, s99
s_mul_i32 s99, s99, 3
s_add_u32 s27, s27, s99
L_e5:
s_waitcnt vmcnt(9)
s_cmp_ge_u32 s27, 34
s_cbranch_scc1 L_w74
s_waitcnt vmcnt(4)
L_w74:
buffer_load_dwordx4 v[140:143], v2, s[40:43], s70 offen offset:2048 nt
s_waitcnt vmcnt(9)
s_cmp_ge_u32 s27, 34
s_cbranch_scc1 L_w75
s_waitcnt vmcnt(4)
L_w75:
buffer_load_dwordx4 v[144:147], v2, s[40:43], s70 offen offset:3072 nt
v_mfma_f32_16x16x32_bf16 v[148:151], v[148:151], v[16:19], 0
v_mfma_f32_16x16x32_bf16 v[152:155], v[152:155], v[16:19], 0
v_mfma_f32_16x16x32_bf16 v[156:159], v[156:159], v[16:19], 0
v_mfma_f32_16x16x32_bf16 v[160:163], v[160:163], v[16:19], 0
s_nop 4
v_mov_b32_dpp v112, v148 quad_perm:[0,0,0,0] row_mask:0xf bank_mask:0xf
v_mov_b32_dpp v113, v152 quad_perm:[0,0,0,0] row_mask:0xf bank_mask:0xf
v_mov_b32_dpp v114, v156 quad_perm:[0,0,0,0] row_mask:0xf bank_mask:0xf
v_mov_b32_dpp v115, v160 quad_perm:[0,0,0,0] row_mask:0xf bank_mask:0xf
v_add_f32_dpp v112, v149, v112 quad_perm:[1,1,1,1] row_mask:0xf bank_mask:0xf
v_add_f32_dpp v113, v153, v113 quad_perm:[1,1,1,1] row_mask:0xf bank_mask:0xf
v_add_f32_dpp v114, v157, v114 quad_perm:[1,1,1,1] row_mask:0xf bank_mask:0xf
v_add_f32_dpp v115, v161, v115 quad_perm:[1,1,1,1] row_mask:0xf bank_mask:0xf
v_add_f32_dpp v112, v150, v112 quad_perm:[2,2,2,2] row_mask:0xf bank_mask:0xf
v_add_f32_dpp v113, v154, v113 quad_perm:[2,2,2,2] row_mask:0xf bank_mask:0xf
v_add_f32_dpp v114, v158, v114 quad_perm:[2,2,2,2] row_mask:0xf bank_mask:0xf
v_add_f32_dpp v115, v162, v115 quad_perm:[2,2,2,2] row_mask:0xf bank_mask:0xf
v_add_f32_dpp v112, v151, v112 quad_perm:[3,3,3,3] row_mask:0xf bank_mask:0xf
v_add_f32_dpp v113, v155, v113 quad_perm:[3,3,3,3] row_mask:0xf bank_mask:0xf
v_add_f32_dpp v114, v159, v114 quad_perm:[3,3,3,3] row_mask:0xf bank_mask:0xf
v_add_f32_dpp v115, v163, v115 quad_perm:[3,3,3,3] row_mask:0xf bank_mask:0xf
v_max_f32 v31, v112, v113
v_max3_f32 v31, v114, v115, v31
s_barrier
s_waitcnt vmcnt(7)
s_cmp_ge_u32 s27, 34
s_cbranch_scc1 L_w76
s_waitcnt vmcnt(4)
L_w76:
s_xor_b32 s70, s69, 393216
buffer_load_dwordx4 v[148:151], v2, s[40:43], s70 offen offset:0 nt
s_add_u32 s30, s24, 5
v_subrev_u32 v189, s30, v190
v_cmp_gt_u32 vcc, 64, v189
s_nop 0
s_bcnt1_i32_b32 s27, vcc_lo
s_and_b32 s99, vcc_hi, 0xff
s_bcnt1_i32_b32 s99, s99
s_mul_i32 s99, s99, 3
s_add_u32 s27, s27, s99
s_waitcnt vmcnt(7)
s_cmp_ge_u32 s27, 34
s_cbranch_scc1 L_w77
s_waitcnt vmcnt(4)
L_w77:
buffer_load_dwordx4 v[152:155], v2, s[40:43], s70 offen offset:1024 nt
s_waitcnt vmcnt(7)
s_cmp_ge_u32 s27, 34
s_cbranch_scc1 L_w78
s_waitcnt vmcnt(4)
L_w78:
buffer_load_dwordx4 v[156:159], v2, s[40:43], s70 offen offset:2048 nt
s_waitcnt vmcnt(7)
s_cmp_ge_u32 s27, 34
s_cbranch_scc1 L_w79
s_waitcnt vmcnt(4)
L_w79:
buffer_load_dwordx4 v[160:163], v2, s[40:43], s70 offen offset:3072 nt
v_mfma_f32_16x16x32_bf16 v[128:131], v[128:131], v[16:19], 0
v_mfma_f32_16x16x32_bf16 v[164:167], v[164:167], v[16:19], 0
v_mfma_f32_16x16x32_bf16 v[168:171], v[168:171], v[16:19], 0
v_mfma_f32_16x16x32_bf16 v[172:175], v[172:175], v[16:19], 0
s_nop 4
v_mov_b32_dpp v116, v128 quad_perm:[0,0,0,0] row_mask:0xf bank_mask:0xf
v_mov_b32_dpp v117, v164 quad_perm:[0,0,0,0] row_mask:0xf bank_mask:0xf
v_mov_b32_dpp v118, v168 quad_perm:[0,0,0,0] row_mask:0xf bank_mask:0xf
v_mov_b32_dpp v119, v172 quad_perm:[0,0,0,0] row_mask:0xf bank_mask:0xf
v_add_f32_dpp v116, v129, v116 quad_perm:[1,1,1,1] row_mask:0xf bank_mask:0xf
v_add_f32_dpp v117, v165, v117 quad_perm:[1,1,1,1] row_mask:0xf bank_mask:0xf
v_add_f32_dpp v118, v169, v118 quad_perm:[1,1,1,1] row_mask:0xf bank_mask:0xf
v_add_f32_dpp v119, v173, v119 quad_perm:[1,1,1,1] row_mask:0xf bank_mask:0xf
v_add_f32_dpp v116, v130, v116 quad_perm:[2,2,2,2] row_mask:0xf bank_mask:0xf
v_add_f32_dpp v117, v166, v117 quad_perm:[2,2,2,2] row_mask:0xf bank_mask:0xf
v_add_f32_dpp v118, v170, v118 quad_perm:[2,2,2,2] row_mask:0xf bank_mask:0xf
v_add_f32_dpp v119, v174, v119 quad_perm:[2,2,2,2] row_mask:0xf bank_mask:0xf
v_add_f32_dpp v116, v131, v116 quad_perm:[3,3,3,3] row_mask:0xf bank_mask:0xf
v_add_f32_dpp v117, v167, v117 quad_perm:[3,3,3,3] row_mask:0xf bank_mask:0xf
v_add_f32_dpp v118, v171, v118 quad_perm:[3,3,3,3] row_mask:0xf bank_mask:0xf
v_add_f32_dpp v119, v175, v119 quad_perm:[3,3,3,3] row_mask:0xf bank_mask:0xf
v_max3_f32 v31, v116, v117, v31
v_max3_f32 v31, v118, v119, v31
s_add_u32 s30, s24, 6
v_mov_b32 v189, s30
s_mov_b32 exec_hi, 0xff
buffer_load_dword v190, v188, s[60:63], 0 offen nt
s_mov_b64 exec, 1
buffer_store_dword v189, v191, s[60:63], 0 offen
s_mov_b64 exec, -1
s_waitcnt vmcnt(9)
s_cmp_ge_u32 s27, 34
s_cbranch_scc1 L_w80
s_waitcnt vmcnt(6)
L_w80:
s_xor_b32 s70, s69, 0
buffer_load_dwordx4 v[128:131], v3, s[44:47], s70 offen offset:0 nt
s_waitcnt vmcnt(9)
s_cmp_ge_u32 s27, 34
s_cbranch_scc1 L_w81
s_waitcnt vmcnt(6)
L_w81:
buffer_load_dwordx4 v[164:167], v3, s[44:47], s70 offen offset:1024 nt
s_waitcnt vmcnt(9)
s_cmp_ge_u32 s27, 34
s_cbranch_scc1 L_w82
s_waitcnt vmcnt(6)
L_w82:
buffer_load_dwordx4 v[168:171], v3, s[44:47], s70 offen offset:2048 nt
s_waitcnt vmcnt(9)
s_cmp_ge_u32 s27, 34
s_cbranch_scc1 L_w83
s_waitcnt vmcnt(6)
L_w83:
buffer_load_dwordx4 v[172:175], v3, s[44:47], s70 offen offset:3072 nt
v_mfma_f32_16x16x32_bf16 v[132:135], v[132:135], v[16:19], 0
v_mfma_f32_16x16x32_bf16 v[136:139], v[136:139], v[16:19], 0
v_mfma_f32_16x16x32_bf16 v[140:143], v[140:143], v[16:19], 0
v_mfma_f32_16x16x32_bf16 v[144:147], v[144:147], v[16:19], 0
s_nop 4
v_mov_b32_dpp v120, v132 quad_perm:[0,0,0,0] row_mask:0xf bank_mask:0xf
v_mov_b32_dpp v121, v136 quad_perm:[0,0,0,0] row_mask:0xf bank_mask:0xf
v_mov_b32_dpp v122, v140 quad_perm:[0,0,0,0] row_mask:0xf bank_mask:0xf
v_mov_b32_dpp v123, v144 quad_perm:[0,0,0,0] row_mask:0xf bank_mask:0xf
v_add_f32_dpp v120, v133, v120 quad_perm:[1,1,1,1] row_mask:0xf bank_mask:0xf
v_add_f32_dpp v121, v137, v121 quad_perm:[1,1,1,1] row_mask:0xf bank_mask:0xf
v_add_f32_dpp v122, v141, v122 quad_perm:[1,1,1,1] row_mask:0xf bank_mask:0xf
v_add_f32_dpp v123, v145, v123 quad_perm:[1,1,1,1] row_mask:0xf bank_mask:0xf
v_add_f32_dpp v120, v134, v120 quad_perm:[2,2,2,2] row_mask:0xf bank_mask:0xf
v_add_f32_dpp v121, v138, v121 quad_perm:[2,2,2,2] row_mask:0xf bank_mask:0xf
v_add_f32_dpp v122, v142, v122 quad_perm:[2,2,2,2] row_mask:0xf bank_mask:0xf
v_add_f32_dpp v123, v146, v123 quad_perm:[2,2,2,2] row_mask:0xf bank_mask:0xf
v_add_f32_dpp v120, v135, v120 quad_perm:[3,3,3,3] row_mask:0xf bank_mask:0xf
v_add_f32_dpp v121, v139, v121 quad_perm:[3,3,3,3] row_mask:0xf bank_mask:0xf
v_add_f32_dpp v122, v143, v122 quad_perm:[3,3,3,3] row_mask:0xf bank_mask:0xf
v_add_f32_dpp v123, v147, v123 quad_perm:[3,3,3,3] row_mask:0xf bank_mask:0xf
v_max3_f32 v31, v120, v121, v31
v_max3_f32 v31, v122, v123, v31
s_barrier
s_waitcnt vmcnt(9)
s_cmp_ge_u32 s27, 34
s_cbranch_scc1 L_w84
s_waitcnt vmcnt(6)
L_w84:
s_xor_b32 s70, s69, 131072
buffer_load_dwordx4 v[132:135], v3, s[44:47], s70 offen offset:0 nt
s_waitcnt vmcnt(9)
s_cmp_ge_u32 s27, 34
s_cbranch_scc1 L_w85
s_waitcnt vmcnt(4)
L_w85:
buffer_load_dwordx4 v[136:139], v3, s[44:47], s70 offen offset:1024 nt
s_cmp_ge_u32 s27, 34
s_cbranch_scc1 L_e6
s_add_u32 s30, s24, 6
v_subrev_u32 v189, s30, v190
v_cmp_gt_u32 vcc, 64, v189
s_nop 0
s_bcnt1_i32_b32 s27, vcc_lo
s_and_b32 s99, vcc_hi, 0xff
s_bcnt1_i32_b32 s99, s99
s_mul_i32 s99, s99, 3
s_add_u32 s27, s27, s99
L_e6:
s_waitcnt vmcnt(9)
s_cmp_ge_u32 s27, 34
s_cbranch_scc1 L_w86
s_waitcnt vmcnt(4)
L_w86:
buffer_load_dwordx4 v[140:143], v3, s[44:47], s70 offen offset:2048 nt
s_waitcnt vmcnt(9)
s_cmp_ge_u32 s27, 34
s_cbranch_scc1 L_w87
s_waitcnt vmcnt(4)
L_w87:
buffer_load_dwordx4 v[144:147], v3, s[44:47], s70 offen offset:3072 nt
v_mfma_f32_16x16x32_bf16 v[148:151], v[148:151], v[16:19], 0
v_mfma_f32_16x16x32_bf16 v[152:155], v[152:155], v[16:19], 0
v_mfma_f32_16x16x32_bf16 v[156:159], v[156:159], v[16:19], 0
v_mfma_f32_16x16x32_bf16 v[160:163], v[160:163], v[16:19], 0
s_nop 4
v_mov_b32_dpp v124, v148 quad_perm:[0,0,0,0] row_mask:0xf bank_mask:0xf
v_mov_b32_dpp v125, v152 quad_perm:[0,0,0,0] row_mask:0xf bank_mask:0xf
v_mov_b32_dpp v126, v156 quad_perm:[0,0,0,0] row_mask:0xf bank_mask:0xf
v_mov_b32_dpp v127, v160 quad_perm:[0,0,0,0] row_mask:0xf bank_mask:0xf
v_add_f32_dpp v124, v149, v124 quad_perm:[1,1,1,1] row_mask:0xf bank_mask:0xf
v_add_f32_dpp v125, v153, v125 quad_perm:[1,1,1,1] row_mask:0xf bank_mask:0xf
v_add_f32_dpp v126, v157, v126 quad_perm:[1,1,1,1] row_mask:0xf bank_mask:0xf
v_add_f32_dpp v127, v161, v127 quad_perm:[1,1,1,1] row_mask:0xf bank_mask:0xf
v_add_f32_dpp v124, v150, v124 quad_perm:[2,2,2,2] row_mask:0xf bank_mask:0xf
v_add_f32_dpp v125, v154, v125 quad_perm:[2,2,2,2] row_mask:0xf bank_mask:0xf
v_add_f32_dpp v126, v158, v126 quad_perm:[2,2,2,2] row_mask:0xf bank_mask:0xf
v_add_f32_dpp v127, v162, v127 quad_perm:[2,2,2,2] row_mask:0xf bank_mask:0xf
v_add_f32_dpp v124, v151, v124 quad_perm:[3,3,3,3] row_mask:0xf bank_mask:0xf
v_add_f32_dpp v125, v155, v125 quad_perm:[3,3,3,3] row_mask:0xf bank_mask:0xf
v_add_f32_dpp v126, v159, v126 quad_perm:[3,3,3,3] row_mask:0xf bank_mask:0xf
v_add_f32_dpp v127, v163, v127 quad_perm:[3,3,3,3] row_mask:0xf bank_mask:0xf
v_max3_f32 v31, v124, v125, v31
v_max3_f32 v31, v126, v127, v31
s_waitcnt vmcnt(7)
s_cmp_ge_u32 s27, 34
s_cbranch_scc1 L_w88
s_waitcnt vmcnt(4)
L_w88:
s_xor_b32 s70, s69, 262144
buffer_load_dwordx4 v[148:151], v3, s[44:47], s70 offen offset:0 nt
v_lshrrev_b32 v40, 2, v11
v_lshlrev_b32 v40, 6, v40
v_lshl_add_u32 v41, v10, 2, v40
s_lshl_b32 s30, s3, 4
v_add_u32 v41, s30, v41
ds_write_b32 v41, v30 offset:39424
ds_write_b32 v41, v31 offset:39680
s_add_u32 s30, s24, 6
v_subrev_u32 v189, s30, v190
v_cmp_gt_u32 vcc, 64, v189
s_nop 0
s_bcnt1_i32_b32 s27, vcc_lo
s_and_b32 s99, vcc_hi, 0xff
s_bcnt1_i32_b32 s99, s99
s_mul_i32 s99, s99, 3
s_add_u32 s27, s27, s99
s_waitcnt vmcnt(7)
s_cmp_ge_u32 s27, 34
s_cbranch_scc1 L_w89
s_waitcnt vmcnt(4)
L_w89:
buffer_load_dwordx4 v[152:155], v3, s[44:47], s70 offen offset:1024 nt
s_waitcnt lgkmcnt(0)
s_barrier
ds_read_b128 v[20:23], v40 offset:39680
ds_read_b128 v[24:27], v40 offset:39696
ds_read_b128 v[32:35], v40 offset:39712
ds_read_b128 v[36:39], v40 offset:39728
s_waitcnt lgkmcnt(0)
v_max3_f32 v20, v20, v21, v22
v_max3_f32 v24, v24, v25, v26
v_max3_f32 v32, v32, v33, v34
v_max3_f32 v36, v36, v37, v38
v_max3_f32 v20, v20, v23, v24
v_max3_f32 v32, v32, v35, v36
v_max3_f32 v20, v20, v27, v39
v_max_f32 v20, v20, v32
v_mul_f32 v31, s71, v20
v_cmp_lt_f32 vcc, 0, v31
v_add_u32 v20, 0xff, v31
s_nop 0
v_cndmask_b32 v31, v31, v20, vcc
v_and_b32 v31, s72, v31
s_waitcnt vmcnt(7)
s_cmp_ge_u32 s27, 34
s_cbranch_scc1 L_w90
s_waitcnt vmcnt(4)
L_w90:
buffer_load_dwordx4 v[156:159], v3, s[44:47], s70 offen offset:2048 nt
ds_read_b128 v[20:23], v40 offset:39424
ds_read_b128 v[24:27], v40 offset:39440
ds_read_b128 v[32:35], v40 offset:39456
ds_read_b128 v[36:39], v40 offset:39472
s_waitcnt lgkmcnt(0)
v_max3_f32 v20, v20, v21, v22
v_max3_f32 v24, v24, v25, v26
v_max3_f32 v32, v32, v33, v34
v_max3_f32 v36, v36, v37, v38
v_max3_f32 v20, v20, v23, v24
v_max3_f32 v32, v32, v35, v36
v_max3_f32 v20, v20, v27, v39
v_max_f32 v20, v20, v32
v_mul_f32 v30, s71, v20
v_cmp_lt_f32 vcc, 0, v30
v_add_u32 v20, 0xff, v30
s_nop 0
v_cndmask_b32 v30, v30, v20, vcc
v_and_b32 v30, s72, v30
s_waitcnt vmcnt(7)
s_cmp_ge_u32 s27, 34
s_cbranch_scc1 L_w91
s_waitcnt vmcnt(4)
L_w91:
buffer_load_dwordx4 v[160:163], v3, s[44:47], s70 offen offset:3072 nt
v_mov_b32 v28, 0
v_mov_b32 v29, 0
v_fma_f32 v112, v112, s71, -v31
v_fma_f32 v113, v113, s71, -v31
v_fma_f32 v114, v114, s71, -v31
v_fma_f32 v115, v115, s71, -v31
v_exp_f32 v112, v112
v_exp_f32 v113, v113
v_exp_f32 v114, v114
v_exp_f32 v115, v115
v_add_f32 v36, v112, v113
v_add_f32 v37, v114, v115
v_add_f32 v29, v29, v36
v_add_f32 v29, v29, v37
v_cvt_pk_bf16_f32 v112, v112, v112
v_cvt_pk_bf16_f32 v113, v113, v113
v_cvt_pk_bf16_f32 v114, v114, v114
v_cvt_pk_bf16_f32 v115, v115, v115
v_fma_f32 v116, v116, s71, -v31
v_fma_f32 v117, v117, s71, -v31
v_fma_f32 v118, v118, s71, -v31
v_fma_f32 v119, v119, s71, -v31
v_exp_f32 v116, v116
v_exp_f32 v117, v117
v_exp_f32 v118, v118
v_exp_f32 v119, v119
v_add_f32 v36, v116, v117
v_add_f32 v37, v118, v119
v_add_f32 v29, v29, v36
v_add_f32 v29, v29, v37
v_cvt_pk_bf16_f32 v116, v116, v116
v_cvt_pk_bf16_f32 v117, v117, v117
v_cvt_pk_bf16_f32 v118, v118, v118
v_cvt_pk_bf16_f32 v119, v119, v119
s_barrier
s_add_u32 s30, s24, 7
v_mov_b32 v189, s30
s_cmp_eq_u32 s26, 0
s_cbranch_scc1 L_ga7
s_mov_b32 s25, 1
s_atomic_add s25, s[100:101], 196 glc
L_ga7:
s_mov_b32 exec_hi, 0xff
buffer_load_dword v190, v188, s[60:63], 0 offen nt
s_mov_b64 exec, 1
buffer_store_dword v189, v191, s[60:63], 0 offen
s_mov_b64 exec, -1
s_waitcnt vmcnt(9)
s_cmp_ge_u32 s27, 34
s_cbranch_scc1 L_w92
s_waitcnt vmcnt(6)
L_w92:
s_xor_b32 s70, s69, 393216
buffer_load_dwordx4 v[176:179], v3, s[44:47], s70 offen offset:0 nt
v_fma_f32 v120, v120, s71, -v31
v_fma_f32 v121, v121, s71, -v31
v_fma_f32 v122, v122, s71, -v31
v_fma_f32 v123, v123, s71, -v31
v_exp_f32 v120, v120
v_exp_f32 v121, v121
v_exp_f32 v122, v122
v_exp_f32 v123, v123
v_add_f32 v36, v120, v121
v_add_f32 v37, v122, v123
v_add_f32 v29, v29, v36
v_add_f32 v29, v29, v37
v_cvt_pk_bf16_f32 v120, v120, v120
v_cvt_pk_bf16_f32 v121, v121, v121
v_cvt_pk_bf16_f32 v122, v122, v122
v_cvt_pk_bf16_f32 v123, v123, v123
v_fma_f32 v124, v124, s71, -v31
v_fma_f32 v125, v125, s71, -v31
v_fma_f32 v126, v126, s71, -v31
v_fma_f32 v127, v127, s71, -v31
v_exp_f32 v124, v124
v_exp_f32 v125, v125
v_exp_f32 v126, v126
v_exp_f32 v127, v127
v_add_f32 v36, v124, v125
v_add_f32 v37, v126, v127
v_add_f32 v29, v29, v36
v_add_f32 v29, v29, v37
v_cvt_pk_bf16_f32 v124, v124, v124
v_cvt_pk_bf16_f32 v125, v125, v125
v_cvt_pk_bf16_f32 v126, v126, v126
v_cvt_pk_bf16_f32 v127, v127, v127
s_waitcnt vmcnt(9)
s_cmp_ge_u32 s27, 34
s_cbranch_scc1 L_w93
s_waitcnt vmcnt(6)
L_w93:
buffer_load_dwordx4 v[180:183], v3, s[44:47], s70 offen offset:1024 nt
v_fma_f32 v48, v48, s71, -v30
v_fma_f32 v49, v49, s71, -v30
v_fma_f32 v50, v50, s71, -v30
v_fma_f32 v51, v51, s71, -v30
v_exp_f32 v48, v48
v_exp_f32 v49, v49
v_exp_f32 v50, v50
v_exp_f32 v51, v51
v_add_f32 v36, v48, v49
v_add_f32 v37, v50, v51
v_add_f32 v28, v28, v36
v_add_f32 v28, v28, v37
v_cvt_pk_bf16_f32 v48, v48, v48
v_cvt_pk_bf16_f32 v49, v49, v49
v_cvt_pk_bf16_f32 v50, v50, v50
v_cvt_pk_bf16_f32 v51, v51, v51
v_fma_f32 v52, v52, s71, -v30
v_fma_f32 v53, v53, s71, -v30
v_fma_f32 v54, v54, s71, -v30
v_fma_f32 v55, v55, s71, -v30
v_exp_f32 v52, v52
v_exp_f32 v53, v53
v_exp_f32 v54, v54
v_exp_f32 v55, v55
v_add_f32 v36, v52, v53
v_add_f32 v37, v54, v55
v_add_f32 v28, v28, v36
v_add_f32 v28, v28, v37
v_cvt_pk_bf16_f32 v52, v52, v52
v_cvt_pk_bf16_f32 v53, v53, v53
v_cvt_pk_bf16_f32 v54, v54, v54
v_cvt_pk_bf16_f32 v55, v55, v55
s_waitcnt vmcnt(9)
s_cmp_ge_u32 s27, 34
s_cbranch_scc1 L_w94
s_waitcnt vmcnt(6)
L_w94:
buffer_load_dwordx4 v[184:187], v3, s[44:47], s70 offen offset:2048 nt
v_fma_f32 v56, v56, s71, -v30
v_fma_f32 v57, v57, s71, -v30
v_fma_f32 v58, v58, s71, -v30
v_fma_f32 v59, v59, s71, -v30
v_exp_f32 v56, v56
v_exp_f32 v57, v57
v_exp_f32 v58, v58
v_exp_f32 v59, v59
v_add_f32 v36, v56, v57
v_add_f32 v37, v58, v59
v_add_f32 v28, v28, v36
v_add_f32 v28, v28, v37
v_cvt_pk_bf16_f32 v56, v56, v56
v_cvt_pk_bf16_f32 v57, v57, v57
v_cvt_pk_bf16_f32 v58, v58, v58
v_cvt_pk_bf16_f32 v59, v59, v59
v_fma_f32 v60, v60, s71, -v30
v_fma_f32 v61, v61, s71, -v30
v_fma_f32 v62, v62, s71, -v30
v_fma_f32 v63, v63, s71, -v30
v_exp_f32 v60, v60
v_exp_f32 v61, v61
v_exp_f32 v62, v62
v_exp_f32 v63, v63
v_add_f32 v36, v60, v61
v_add_f32 v37, v62, v63
v_add_f32 v28, v28, v36
v_add_f32 v28, v28, v37
v_cvt_pk_bf16_f32 v60, v60, v60
v_cvt_pk_bf16_f32 v61, v61, v61
v_cvt_pk_bf16_f32 v62, v62, v62
v_cvt_pk_bf16_f32 v63, v63, v63
s_waitcnt vmcnt(9)
s_cmp_ge_u32 s27, 34
s_cbranch_scc1 L_w95
s_waitcnt vmcnt(6)
L_w95:
buffer_load_dwordx4 v[192:195], v3, s[44:47], s70 offen offset:3072 nt
v_fma_f32 v64, v64, s71, -v30
v_fma_f32 v65, v65, s71, -v30
v_fma_f32 v66, v66, s71, -v30
v_fma_f32 v67, v67, s71, -v30
v_exp_f32 v64, v64
v_exp_f32 v65, v65
v_exp_f32 v66, v66
v_exp_f32 v67, v67
v_add_f32 v36, v64, v65
v_add_f32 v37, v66, v67
v_add_f32 v28, v28, v36
v_add_f32 v28, v28, v37
v_cvt_pk_bf16_f32 v64, v64, v64
v_cvt_pk_bf16_f32 v65, v65, v65
v_cvt_pk_bf16_f32 v66, v66, v66
v_cvt_pk_bf16_f32 v67, v67, v67
v_fma_f32 v68, v68, s71, -v30
v_fma_f32 v69, v69, s71, -v30
v_fma_f32 v70, v70, s71, -v30
v_fma_f32 v71, v71, s71, -v30
v_exp_f32 v68, v68
v_exp_f32 v69, v69
v_exp_f32 v70, v70
v_exp_f32 v71, v71
v_add_f32 v36, v68, v69
v_add_f32 v37, v70, v71
v_add_f32 v28, v28, v36
v_add_f32 v28, v28, v37
v_cvt_pk_bf16_f32 v68, v68, v68
v_cvt_pk_bf16_f32 v69, v69, v69
v_cvt_pk_bf16_f32 v70, v70, v70
v_cvt_pk_bf16_f32 v71, v71, v71
s_waitcnt vmcnt(9)
s_cmp_ge_u32 s27, 34
s_cbranch_scc1 L_w96
s_waitcnt vmcnt(6)
L_w96:
s_xor_b32 s70, s68, 0
buffer_load_dwordx4 v[196:199], v3, s[36:39], s70 offen offset:0 nt
v_fma_f32 v72, v72, s71, -v30
v_fma_f32 v73, v73, s71, -v30
v_fma_f32 v74, v74, s71, -v30
v_fma_f32 v75, v75, s71, -v30
v_exp_f32 v72, v72
v_exp_f32 v73, v73
v_exp_f32 v74, v74
v_exp_f32 v75, v75
v_add_f32 v36, v72, v73
v_add_f32 v37, v74, v75
v_add_f32 v28, v28, v36
v_add_f32 v28, v28, v37
v_cvt_pk_bf16_f32 v72, v72, v72
v_cvt_pk_bf16_f32 v73, v73, v73
v_cvt_pk_bf16_f32 v74, v74, v74
v_cvt_pk_bf16_f32 v75, v75, v75
v_fma_f32 v76, v76, s71, -v30
v_fma_f32 v77, v77, s71, -v30
v_fma_f32 v78, v78, s71, -v30
v_fma_f32 v79, v79, s71, -v30
v_exp_f32 v76, v76
v_exp_f32 v77, v77
v_exp_f32 v78, v78
v_exp_f32 v79, v79
v_add_f32 v36, v76, v77
v_add_f32 v37, v78, v79
v_add_f32 v28, v28, v36
v_add_f32 v28, v28, v37
v_cvt_pk_bf16_f32 v76, v76, v76
v_cvt_pk_bf16_f32 v77, v77, v77
v_cvt_pk_bf16_f32 v78, v78, v78
v_cvt_pk_bf16_f32 v79, v79, v79
s_waitcnt vmcnt(9)
s_cmp_ge_u32 s27, 34
s_cbranch_scc1 L_w97
s_waitcnt vmcnt(4)
L_w97:
buffer_load_dwordx4 v[200:203], v3, s[36:39], s70 offen offset:1024 nt
v_fma_f32 v80, v80, s71, -v30
v_fma_f32 v81, v81, s71, -v30
v_fma_f32 v82, v82, s71, -v30
v_fma_f32 v83, v83, s71, -v30
v_exp_f32 v80, v80
v_exp_f32 v81, v81
v_exp_f32 v82, v82
v_exp_f32 v83, v83
v_add_f32 v36, v80, v81
v_add_f32 v37, v82, v83
v_add_f32 v28, v28, v36
v_add_f32 v28, v28, v37
v_cvt_pk_bf16_f32 v80, v80, v80
v_cvt_pk_bf16_f32 v81, v81, v81
v_cvt_pk_bf16_f32 v82, v82, v82
v_cvt_pk_bf16_f32 v83, v83, v83
v_fma_f32 v84, v84, s71, -v30
v_fma_f32 v85, v85, s71, -v30
v_fma_f32 v86, v86, s71, -v30
v_fma_f32 v87, v87, s71, -v30
v_exp_f32 v84, v84
v_exp_f32 v85, v85
v_exp_f32 v86, v86
v_exp_f32 v87, v87
v_add_f32 v36, v84, v85
v_add_f32 v37, v86, v87
v_add_f32 v28, v28, v36
v_add_f32 v28, v28, v37
v_cvt_pk_bf16_f32 v84, v84, v84
v_cvt_pk_bf16_f32 v85, v85, v85
v_cvt_pk_bf16_f32 v86, v86, v86
v_cvt_pk_bf16_f32 v87, v87, v87
s_cmp_ge_u32 s27, 34
s_cbranch_scc1 L_e7
s_add_u32 s30, s24, 7
v_subrev_u32 v189, s30, v190
v_cmp_gt_u32 vcc, 64, v189
s_nop 0
s_bcnt1_i32_b32 s27, vcc_lo
s_and_b32 s99, vcc_hi, 0xff
s_bcnt1_i32_b32 s99, s99
s_mul_i32 s99, s99, 3
s_add_u32 s27, s27, s99
L_e7:
s_waitcnt vmcnt(9)
s_cmp_ge_u32 s27, 34
s_cbranch_scc1 L_w98
s_waitcnt vmcnt(4)
L_w98:
buffer_load_dwordx4 v[204:207], v3, s[36:39], s70 offen offset:2048 nt
v_fma_f32 v88, v88, s71, -v30
v_fma_f32 v89, v89, s71, -v30
v_fma_f32 v90, v90, s71, -v30
v_fma_f32 v91, v91, s71, -v30
v_exp_f32 v88, v88
v_exp_f32 v89, v89
v_exp_f32 v90, v90
v_exp_f32 v91, v91
v_add_f32 v36, v88, v89
v_add_f32 v37, v90, v91
v_add_f32 v28, v28, v36
v_add_f32 v28, v28, v37
v_cvt_pk_bf16_f32 v88, v88, v88
v_cvt_pk_bf16_f32 v89, v89, v89
v_cvt_pk_bf16_f32 v90, v90, v90
v_cvt_pk_bf16_f32 v91, v91, v91
v_fma_f32 v92, v92, s71, -v30
v_fma_f32 v93, v93, s71, -v30
v_fma_f32 v94, v94, s71, -v30
v_fma_f32 v95, v95, s71, -v30
v_exp_f32 v92, v92
v_exp_f32 v93, v93
v_exp_f32 v94, v94
v_exp_f32 v95, v95
v_add_f32 v36, v92, v93
v_add_f32 v37, v94, v95
v_add_f32 v28, v28, v36
v_add_f32 v28, v28, v37
v_cvt_pk_bf16_f32 v92, v92, v92
v_cvt_pk_bf16_f32 v93, v93, v93
v_cvt_pk_bf16_f32 v94, v94, v94
v_cvt_pk_bf16_f32 v95, v95, v95
s_waitcnt vmcnt(9)
s_cmp_ge_u32 s27, 34
s_cbranch_scc1 L_w99
s_waitcnt vmcnt(4)
L_w99:
buffer_load_dwordx4 v[208:211], v3, s[36:39], s70 offen offset:3072 nt
v_fma_f32 v96, v96, s71, -v30
v_fma_f32 v97, v97, s71, -v30
v_fma_f32 v98, v98, s71, -v30
v_fma_f32 v99, v99, s71, -v30
v_exp_f32 v96, v96
v_exp_f32 v97, v97
v_exp_f32 v98, v98
v_exp_f32 v99, v99
v_add_f32 v36, v96, v97
v_add_f32 v37, v98, v99
v_add_f32 v28, v28, v36
v_add_f32 v28, v28, v37
v_cvt_pk_bf16_f32 v96, v96, v96
v_cvt_pk_bf16_f32 v97, v97, v97
v_cvt_pk_bf16_f32 v98, v98, v98
v_cvt_pk_bf16_f32 v99, v99, v99
v_fma_f32 v100, v100, s71, -v30
v_fma_f32 v101, v101, s71, -v30
v_fma_f32 v102, v102, s71, -v30
v_fma_f32 v103, v103, s71, -v30
v_exp_f32 v100, v100
v_exp_f32 v101, v101
v_exp_f32 v102, v102
v_exp_f32 v103, v103
v_add_f32 v36, v100, v101
v_add_f32 v37, v102, v103
v_add_f32 v28, v28, v36
v_add_f32 v28, v28, v37
v_cvt_pk_bf16_f32 v100, v100, v100
v_cvt_pk_bf16_f32 v101, v101, v101
v_cvt_pk_bf16_f32 v102, v102, v102
v_cvt_pk_bf16_f32 v103, v103, v103
s_barrier
s_waitcnt vmcnt(7)
s_cmp_ge_u32 s27, 34
s_cbranch_scc1 L_w100
s_waitcnt vmcnt(4)
L_w100:
s_xor_b32 s70, s68, 16384
buffer_load_dwordx4 v[212:215], v3, s[36:39], s70 offen offset:0 nt
v_fma_f32 v104, v104, s71, -v30
v_fma_f32 v105, v105, s71, -v30
v_fma_f32 v106, v106, s71, -v30
v_fma_f32 v107, v107, s71, -v30
v_exp_f32 v104, v104
v_exp_f32 v105, v105
v_exp_f32 v106, v106
v_exp_f32 v107, v107
v_add_f32 v36, v104, v105
v_add_f32 v37, v106, v107
v_add_f32 v28, v28, v36
v_add_f32 v28, v28, v37
v_cvt_pk_bf16_f32 v104, v104, v104
v_cvt_pk_bf16_f32 v105, v105, v105
v_cvt_pk_bf16_f32 v106, v106, v106
v_cvt_pk_bf16_f32 v107, v107, v107
v_fma_f32 v108, v108, s71, -v30
v_fma_f32 v109, v109, s71, -v30
v_fma_f32 v110, v110, s71, -v30
v_fma_f32 v111, v111, s71, -v30
v_exp_f32 v108, v108
v_exp_f32 v109, v109
v_exp_f32 v110, v110
v_exp_f32 v111, v111
v_add_f32 v36, v108, v109
v_add_f32 v37, v110, v111
v_add_f32 v28, v28, v36
v_add_f32 v28, v28, v37
v_cvt_pk_bf16_f32 v108, v108, v108
v_cvt_pk_bf16_f32 v109, v109, v109
v_cvt_pk_bf16_f32 v110, v110, v110
v_cvt_pk_bf16_f32 v111, v111, v111
s_add_u32 s30, s24, 7
v_subrev_u32 v189, s30, v190
v_cmp_gt_u32 vcc, 64, v189
s_nop 0
s_bcnt1_i32_b32 s27, vcc_lo
s_and_b32 s99, vcc_hi, 0xff
s_bcnt1_i32_b32 s99, s99
s_mul_i32 s99, s99, 3
s_add_u32 s27, s27, s99
s_waitcnt lgkmcnt(0)
s_bitcmp1_b32 s25, 5
s_cselect_b32 s30, 63, -1
s_add_u32 s30, s30, s24
v_mov_b32 v189, s30
s_mov_b64 exec, 2
buffer_store_dword v189, v191, s[60:63], 0 offen
s_mov_b64 exec, -1
s_waitcnt vmcnt(8)
s_cmp_ge_u32 s27, 34
s_cbranch_scc1 L_w101
s_waitcnt vmcnt(5)
L_w101:
buffer_load_dwordx4 v[216:219], v3, s[36:39], s70 offen offset:1024 nt
v_permlane32_swap_b32 v28, v29
v_add_f32 v28, v28, v29
s_mul_i32 s30, s3, 2176
v_and_b32 v40, 12, v11
v_add_u32 v40, v40, v10
v_lshl_add_u32 v40, v40, 2, s30
ds_write_b32 v40, v28 offset:41984
v_lshl_add_u32 v40, v1, 5, s30
s_lshl_b32 s30, s3, 9
s_lshl_b32 s31, s3, 4
s_add_u32 s31, s31, 2048
v_add_u32 v41, s30, v3
v_mov_b32 v36, s31
v_cmp_gt_u32 vcc, 32, v1
s_nop 1
v_cndmask_b32 v41, v36, v41, vcc
s_lshl_b32 s30, s3, 2
s_lshl_b32 s8, 1, s30
s_waitcnt vmcnt(8)
s_cmp_ge_u32 s27, 34
s_cbranch_scc1 L_w102
s_waitcnt vmcnt(5)
L_w102:
buffer_load_dwordx4 v[220:223], v3, s[36:39], s70 offen offset:2048 nt
s_and_b32 s30, s2, 31
s_lshl_b32 s30, s30, 2
s_add_u32 s30, s30, s3
s_lshl_b32 s30, s30, 3
s_lshr_b32 s31, s2, 5
s_add_u32 s30, s30, s31
s_lshl_b32 s7, s30, 8
s_add_u32 s7, s7, 1048576
s_lshl_b32 s21, s30, 4
s_add_u32 s21, s21, 294912
v_and_b32 v42, 31, v1
v_lshlrev_b32 v42, 3, v42
v_and_b32 v32, v112, v4
v_and_b32 v33, v112, v5
s_nop 1
v_mfma_f32_16x16x16_bf16 v[20:23], v[32:33], v[128:129], 0
v_mfma_f32_16x16x16_bf16 v[24:27], v[32:33], v[130:131], 0
v_and_b32 v34, v113, v4
v_and_b32 v35, v113, v5
s_nop 1
v_mfma_f32_16x16x16_bf16 v[20:23], v[34:35], v[164:165], v[20:23]
v_mfma_f32_16x16x16_bf16 v[24:27], v[34:35], v[166:167], v[24:27]
v_and_b32 v32, v114, v4
v_and_b32 v33, v114, v5
s_waitcnt vmcnt(8)
s_cmp_ge_u32 s27, 34
s_cbranch_scc1 L_w103
s_waitcnt vmcnt(5)
L_w103:
buffer_load_dwordx4 v[128:131], v3, s[36:39], s70 offen offset:3072 nt
v_mfma_f32_16x16x16_bf16 v[20:23], v[32:33], v[168:169], v[20:23]
v_mfma_f32_16x16x16_bf16 v[24:27], v[32:33], v[170:171], v[24:27]
v_and_b32 v34, v115, v4
v_and_b32 v35, v115, v5
s_nop 1
v_mfma_f32_16x16x16_bf16 v[20:23], v[34:35], v[172:173], v[20:23]
v_mfma_f32_16x16x16_bf16 v[24:27], v[34:35], v[174:175], v[24:27]
v_and_b32 v32, v116, v4
v_and_b32 v33, v116, v5
s_nop 1
v_mfma_f32_16x16x16_bf16 v[20:23], v[32:33], v[132:133], v[20:23]
v_mfma_f32_16x16x16_bf16 v[24:27], v[32:33], v[134:135], v[24:27]
v_and_b32 v34, v117, v4
v_and_b32 v35, v117, v5
s_nop 1
v_mfma_f32_16x16x16_bf16 v[20:23], v[34:35], v[136:137], v[20:23]
v_mfma_f32_16x16x16_bf16 v[24:27], v[34:35], v[138:139], v[24:27]
v_and_b32 v32, v118, v4
v_and_b32 v33, v118, v5
s_add_u32 s30, s24, 8
v_mov_b32 v189, s30
s_mov_b32 exec_hi, 0xff
buffer_load_dword v190, v188, s[60:63], 0 offen nt
s_mov_b64 exec, 1
buffer_store_dword v189, v191, s[60:63], 0 offen
s_mov_b64 exec, -1
s_waitcnt vmcnt(10)
s_cmp_ge_u32 s27, 34
s_cbranch_scc1 L_w104
s_waitcnt vmcnt(7)
L_w104:
s_xor_b32 s70, s68, 65536
buffer_load_dwordx4 v[132:135], v3, s[36:39], s70 offen offset:0 nt
v_mfma_f32_16x16x16_bf16 v[20:23], v[32:33], v[140:141], v[20:23]
v_mfma_f32_16x16x16_bf16 v[24:27], v[32:33], v[142:143], v[24:27]
v_and_b32 v34, v119, v4
v_and_b32 v35, v119, v5
s_nop 1
v_mfma_f32_16x16x16_bf16 v[20:23], v[34:35], v[144:145], v[20:23]
v_mfma_f32_16x16x16_bf16 v[24:27], v[34:35], v[146:147], v[24:27]
v_and_b32 v32, v120, v4
v_and_b32 v33, v120, v5
s_nop 1
v_mfma_f32_16x16x16_bf16 v[20:23], v[32:33], v[148:149], v[20:23]
v_mfma_f32_16x16x16_bf16 v[24:27], v[32:33], v[150:151], v[24:27]
v_and_b32 v34, v121, v4
v_and_b32 v35, v121, v5
s_nop 1
v_mfma_f32_16x16x16_bf16 v[20:23], v[34:35], v[152:153], v[20:23]
v_mfma_f32_16x16x16_bf16 v[24:27], v[34:35], v[154:155], v[24:27]
v_and_b32 v32, v122, v4
v_and_b32 v33, v122, v5
s_waitcnt vmcnt(10)
s_cmp_ge_u32 s27, 34
s_cbranch_scc1 L_w105
s_waitcnt vmcnt(7)
L_w105:
buffer_load_dwordx4 v[136:139], v3, s[36:39], s70 offen offset:1024 nt
v_mfma_f32_16x16x16_bf16 v[20:23], v[32:33], v[156:157], v[20:23]
v_mfma_f32_16x16x16_bf16 v[24:27], v[32:33], v[158:159], v[24:27]
v_and_b32 v34, v123, v4
v_and_b32 v35, v123, v5
s_nop 1
v_mfma_f32_16x16x16_bf16 v[20:23], v[34:35], v[160:161], v[20:23]
v_mfma_f32_16x16x16_bf16 v[24:27], v[34:35], v[162:163], v[24:27]
v_and_b32 v32, v124, v4
v_and_b32 v33, v124, v5
s_nop 1
v_mfma_f32_16x16x16_bf16 v[20:23], v[32:33], v[176:177], v[20:23]
v_mfma_f32_16x16x16_bf16 v[24:27], v[32:33], v[178:179], v[24:27]
v_and_b32 v34, v125, v4
v_and_b32 v35, v125, v5
s_nop 1
v_mfma_f32_16x16x16_bf16 v[20:23], v[34:35], v[180:181], v[20:23]
v_mfma_f32_16x16x16_bf16 v[24:27], v[34:35], v[182:183], v[24:27]
v_and_b32 v32, v126, v4
v_and_b32 v33, v126, v5
s_waitcnt vmcnt(10)
s_cmp_ge_u32 s27, 34
s_cbranch_scc1 L_w106
s_waitcnt vmcnt(6)
L_w106:
buffer_load_dwordx4 v[140:143], v3, s[36:39], s70 offen offset:2048 nt
v_mfma_f32_16x16x16_bf16 v[20:23], v[32:33], v[184:185], v[20:23]
v_mfma_f32_16x16x16_bf16 v[24:27], v[32:33], v[186:187], v[24:27]
v_and_b32 v34, v127, v4
v_and_b32 v35, v127, v5
s_nop 1
v_mfma_f32_16x16x16_bf16 v[20:23], v[34:35], v[192:193], v[20:23]
v_mfma_f32_16x16x16_bf16 v[24:27], v[34:35], v[194:195], v[24:27]
s_nop 6
ds_write_b128 v40, v[20:23] offset:39936
ds_write_b128 v40, v[24:27] offset:39952
s_waitcnt vmcnt(10)
s_cmp_ge_u32 s27, 34
s_cbranch_scc1 L_w107
s_waitcnt vmcnt(6)
L_w107:
buffer_load_dwordx4 v[144:147], v3, s[36:39], s70 offen offset:3072 nt
s_waitcnt lgkmcnt(0)
s_barrier
ds_read_b128 v[20:23], v41 offset:39936
ds_read_b128 v[24:27], v41 offset:42112
ds_read_b128 v[32:35], v41 offset:44288
ds_read_b128 v[36:39], v41 offset:46464
s_waitcnt lgkmcnt(2)
v_pk_add_f32 v[20:21], v[20:21], v[24:25]
v_pk_add_f32 v[22:23], v[22:23], v[26:27]
s_waitcnt lgkmcnt(1)
v_pk_add_f32 v[20:21], v[20:21], v[32:33]
v_pk_add_f32 v[22:23], v[22:23], v[34:35]
s_waitcnt lgkmcnt(0)
v_pk_add_f32 v[20:21], v[20:21], v[36:37]
v_pk_add_f32 v[22:23], v[22:23], v[38:39]
v_cvt_pk_bf16_f32 v118, v20, v21
v_cvt_pk_bf16_f32 v119, v22, v23
v_add_f32 v121, v20, v21
v_add_f32 v123, v22, v23
v_mov_b32 v120, v30
v_mov_b32 v122, v31
v_and_or_b32 v120, v120, s72, v6
v_and_or_b32 v121, v121, s72, v7
v_and_or_b32 v122, v122, s72, v8
v_and_or_b32 v123, v123, s72, v9
s_lshr_b32 s30, s77, 3
s_lshl_b32 s31, s16, 2
s_add_u32 s17, s30, s31
s_lshl_b32 s30, s3, 5
s_add_u32 s30, s30, s17
s_lshl_b32 s11, s30, 7
s_add_u32 s11, s11, 294912
s_lshl_b32 s10, s30, 11
s_add_u32 s10, s10, 1048576
s_add_u32 s5, s10, 0x40000
v_lshlrev_b32 v114, 4, v10
v_lshlrev_b32 v36, 4, v11
v_lshl_add_u32 v36, v10, 2, v36
s_mul_i32 s30, s3, 320
v_add_u32 v115, s30, v36
v_and_b32 v36, 3, v11
v_mul_u32_u24 v116, 320, v36
v_lshl_add_u32 v116, v10, 4, v116
v_lshlrev_b32 v117, 4, v11
v_lshl_add_u32 v117, v10, 6, v117
v_lshrrev_b32 v37, 2, v11
v_lshl_add_u32 v117, v37, 24, v117
s_lshl_b32 s12, s17, 13
s_and_b32 s30, s77, 7
s_lshl_b32 s30, s30, 10
s_add_u32 s12, s12, s30
s_lshl_b32 s30, s3, 8
s_add_u32 s12, s12, s30
s_add_u32 s12, s12, 393216
s_lshl_b32 s31, s3, 5
v_xor_b32 v46, s31, v46
s_add_u32 s6, s12, 0x40000
s_mov_b32 s9, 0xffff0000
s_barrier
s_waitcnt vmcnt(10)
s_cmp_ge_u32 s27, 34
s_cbranch_scc1 L_w108
s_waitcnt vmcnt(6)
L_w108:
s_xor_b32 s70, s68, 81920
buffer_load_dwordx4 v[148:151], v3, s[36:39], s70 offen offset:0 nt
v_and_b32 v45, 0x70, v44
v_lshrrev_b32 v44, 3, v1
v_lshl_add_u32 v44, v44, 10, v45
v_xor_b32 v45, 64, v44
s_lshl_b32 s4, s17, 17
s_and_b32 s30, s77, 7
s_lshl_b32 s30, s30, 7
s_add_u32 s4, s4, s30
s_lshl_b32 s30, s3, 15
s_add_u32 s4, s4, s30
s_lshl_b32 s75, s3, 12
s_mov_b32 s48, s22
s_mov_b32 s49, s23
v_lshrrev_b32 v112, 1, v1
v_lshlrev_b32 v112, 13, v112
v_and_b32 v36, 1, v1
v_lshl_add_u32 v112, v36, 4, v112
s_lshl_b32 s30, s16, 5
s_add_u32 s30, s30, s77
s_and_b32 s31, s3, 1
s_lshl_b32 s13, s31, 18
s_lshl_b32 s15, s30, 5
s_add_u32 s13, s13, s15
s_add_u32 s13, s13, 393216
s_lshl_b32 s15, s31, 10
s_and_b32 s31, s30, 1
s_lshl_b32 s31, s31, 12
s_add_u32 s15, s15, s31
s_lshr_b32 s31, s30, 1
s_lshl_b32 s31, s31, 3
s_add_u32 s15, s15, s31
s_cmp_eq_u32 s3, 3
s_cselect_b32 s17, s13, 2146435072
v_lshl_add_u32 v113, v36, 10, v10
v_lshlrev_b32 v113, 1, v113
v_lshrrev_b32 v36, 1, v11
v_lshl_add_u32 v113, v36, 16, v113
v_and_b32 v32, v48, v4
v_and_b32 v33, v48, v5
s_nop 1
v_mfma_f32_16x16x16_bf16 v[20:23], v[32:33], v[196:197], 0
v_mfma_f32_16x16x16_bf16 v[24:27], v[32:33], v[198:199], 0
v_and_b32 v34, v49, v4
v_and_b32 v35, v49, v5
s_waitcnt vmcnt(9)
s_cmp_ge_u32 s27, 34
s_cbranch_scc1 L_w109
s_waitcnt vmcnt(4)
L_w109:
buffer_load_dwordx4 v[152:155], v3, s[36:39], s70 offen offset:1024 nt
v_mfma_f32_16x16x16_bf16 v[20:23], v[34:35], v[200:201], v[20:23]
v_mfma_f32_16x16x16_bf16 v[24:27], v[34:35], v[202:203], v[24:27]
v_and_b32 v32, v50, v4
v_and_b32 v33, v50, v5
s_nop 1
v_mfma_f32_16x16x16_bf16 v[20:23], v[32:33], v[204:205], v[20:23]
v_mfma_f32_16x16x16_bf16 v[24:27], v[32:33], v[206:207], v[24:27]
v_and_b32 v34, v51, v4
v_and_b32 v35, v51, v5
s_nop 1
v_mfma_f32_16x16x16_bf16 v[20:23], v[34:35], v[208:209], v[20:23]
v_mfma_f32_16x16x16_bf16 v[24:27], v[34:35], v[210:211], v[24:27]
v_and_b32 v32, v52, v4
v_and_b32 v33, v52, v5
s_nop 1
v_mfma_f32_16x16x16_bf16 v[20:23], v[32:33], v[212:213], v[20:23]
v_mfma_f32_16x16x16_bf16 v[24:27], v[32:33], v[214:215], v[24:27]
v_and_b32 v34, v53, v4
v_and_b32 v35, v53, v5
s_cmp_ge_u32 s27, 34
s_cbranch_scc1 L_e8
s_add_u32 s30, s24, 8
v_subrev_u32 v189, s30, v190
v_cmp_gt_u32 vcc, 64, v189
s_nop 0
s_bcnt1_i32_b32 s27, vcc_lo
s_and_b32 s99, vcc_hi, 0xff
s_bcnt1_i32_b32 s99, s99
s_mul_i32 s99, s99, 3
s_add_u32 s27, s27, s99
L_e8:
s_waitcnt vmcnt(9)
s_cmp_ge_u32 s27, 34
s_cbranch_scc1 L_w110
s_waitcnt vmcnt(4)
L_w110:
buffer_load_dwordx4 v[156:159], v3, s[36:39], s70 offen offset:2048 nt
v_mfma_f32_16x16x16_bf16 v[20:23], v[34:35], v[216:217], v[20:23]
v_mfma_f32_16x16x16_bf16 v[24:27], v[34:35], v[218:219], v[24:27]
v_and_b32 v32, v54, v4
v_and_b32 v33, v54, v5
s_nop 1
v_mfma_f32_16x16x16_bf16 v[20:23], v[32:33], v[220:221], v[20:23]
v_mfma_f32_16x16x16_bf16 v[24:27], v[32:33], v[222:223], v[24:27]
v_and_b32 v34, v55, v4
v_and_b32 v35, v55, v5
s_waitcnt vmcnt(9)
s_cmp_ge_u32 s27, 34
s_cbranch_scc1 L_w111
s_waitcnt vmcnt(4)
L_w111:
buffer_load_dwordx4 v[160:163], v3, s[36:39], s70 offen offset:3072 nt
v_mfma_f32_16x16x16_bf16 v[20:23], v[34:35], v[128:129], v[20:23]
v_mfma_f32_16x16x16_bf16 v[24:27], v[34:35], v[130:131], v[24:27]
v_and_b32 v32, v56, v4
v_and_b32 v33, v56, v5
s_waitcnt vmcnt(7)
s_cmp_ge_u32 s27, 34
s_cbranch_scc1 L_w112
s_waitcnt vmcnt(4)
L_w112:
s_xor_b32 s70, s68, 131072
buffer_load_dwordx4 v[128:131], v3, s[36:39], s70 offen offset:0 nt
v_mfma_f32_16x16x16_bf16 v[20:23], v[32:33], v[132:133], v[20:23]
v_mfma_f32_16x16x16_bf16 v[24:27], v[32:33], v[134:135], v[24:27]
v_and_b32 v34, v57, v4
v_and_b32 v35, v57, v5
s_add_u32 s30, s24, 8
v_subrev_u32 v189, s30, v190
v_cmp_gt_u32 vcc, 64, v189
s_nop 0
s_bcnt1_i32_b32 s27, vcc_lo
s_and_b32 s99, vcc_hi, 0xff
s_bcnt1_i32_b32 s99, s99
s_mul_i32 s99, s99, 3
s_add_u32 s27, s27, s99
s_waitcnt vmcnt(7)
s_cmp_ge_u32 s27, 34
s_cbranch_scc1 L_w113
s_waitcnt vmcnt(4)
L_w113:
buffer_load_dwordx4 v[132:135], v3, s[36:39], s70 offen offset:1024 nt
v_mfma_f32_16x16x16_bf16 v[20:23], v[34:35], v[136:137], v[20:23]
v_mfma_f32_16x16x16_bf16 v[24:27], v[34:35], v[138:139], v[24:27]
v_and_b32 v32, v58, v4
v_and_b32 v33, v58, v5
s_waitcnt vmcnt(7)
s_cmp_ge_u32 s27, 34
s_cbranch_scc1 L_w114
s_waitcnt vmcnt(4)
L_w114:
buffer_load_dwordx4 v[136:139], v3, s[36:39], s70 offen offset:2048 nt
v_mfma_f32_16x16x16_bf16 v[20:23], v[32:33], v[140:141], v[20:23]
v_mfma_f32_16x16x16_bf16 v[24:27], v[32:33], v[142:143], v[24:27]
v_and_b32 v34, v59, v4
v_and_b32 v35, v59, v5
s_waitcnt vmcnt(7)
s_cmp_ge_u32 s27, 34
s_cbranch_scc1 L_w115
s_waitcnt vmcnt(4)
L_w115:
buffer_load_dwordx4 v[140:143], v3, s[36:39], s70 offen offset:3072 nt
v_mfma_f32_16x16x16_bf16 v[20:23], v[34:35], v[144:145], v[20:23]
v_mfma_f32_16x16x16_bf16 v[24:27], v[34:35], v[146:147], v[24:27]
v_and_b32 v32, v60, v4
v_and_b32 v33, v60, v5
s_barrier
s_add_u32 s30, s24, 9
v_mov_b32 v189, s30
s_mov_b32 exec_hi, 0xff
buffer_load_dword v190, v188, s[60:63], 0 offen nt
s_mov_b64 exec, 1
buffer_store_dword v189, v191, s[60:63], 0 offen
s_mov_b64 exec, -1
s_waitcnt vmcnt(9)
s_cmp_ge_u32 s27, 34
s_cbranch_scc1 L_w116
s_waitcnt vmcnt(6)
L_w116:
s_xor_b32 s70, s68, 147456
buffer_load_dwordx4 v[144:147], v3, s[36:39], s70 offen offset:0 nt
v_mfma_f32_16x16x16_bf16 v[20:23], v[32:33], v[148:149], v[20:23]
v_mfma_f32_16x16x16_bf16 v[24:27], v[32:33], v[150:151], v[24:27]
v_and_b32 v34, v61, v4
v_and_b32 v35, v61, v5
v_lshrrev_b32 v36, 5, v1
v_lshl_add_u32 v36, v36, 18, v42
v_mov_b32 v38, s20
v_mov_b32 v39, s20
s_cmp_eq_u32 s76, 0
v_permlane32_swap_b32 v38, v118
v_permlane32_swap_b32 v39, v119
s_cbranch_scc0 L_gs0
buffer_store_dwordx2 v[38:39], v36, s[60:63], s7 offen
L_gr0:
s_waitcnt vmcnt(10)
s_cmp_ge_u32 s27, 34
s_cbranch_scc1 L_w117
s_waitcnt vmcnt(7)
L_w117:
buffer_load_dwordx4 v[148:151], v3, s[36:39], s70 offen offset:1024 nt
v_mfma_f32_16x16x16_bf16 v[20:23], v[34:35], v[152:153], v[20:23]
v_mfma_f32_16x16x16_bf16 v[24:27], v[34:35], v[154:155], v[24:27]
v_and_b32 v32, v62, v4
v_and_b32 v33, v62, v5
s_waitcnt vmcnt(10)
s_cmp_ge_u32 s27, 34
s_cbranch_scc1 L_w118
s_waitcnt vmcnt(7)
L_w118:
buffer_load_dwordx4 v[152:155], v3, s[36:39], s70 offen offset:2048 nt
v_mfma_f32_16x16x16_bf16 v[20:23], v[32:33], v[156:157], v[20:23]
v_mfma_f32_16x16x16_bf16 v[24:27], v[32:33], v[158:159], v[24:27]
v_and_b32 v34, v63, v4
v_and_b32 v35, v63, v5
s_waitcnt vmcnt(10)
s_cmp_ge_u32 s27, 34
s_cbranch_scc1 L_w119
s_waitcnt vmcnt(7)
L_w119:
buffer_load_dwordx4 v[156:159], v3, s[36:39], s70 offen offset:3072 nt
v_mfma_f32_16x16x16_bf16 v[20:23], v[34:35], v[160:161], v[20:23]
v_mfma_f32_16x16x16_bf16 v[24:27], v[34:35], v[162:163], v[24:27]
v_and_b32 v32, v64, v4
v_and_b32 v33, v64, v5
s_waitcnt vmcnt(10)
s_cmp_ge_u32 s27, 34
s_cbranch_scc1 L_w120
s_waitcnt vmcnt(7)
L_w120:
s_xor_b32 s70, s68, 196608
buffer_load_dwordx4 v[160:163], v3, s[36:39], s70 offen offset:0 nt
v_mfma_f32_16x16x16_bf16 v[20:23], v[32:33], v[128:129], v[20:23]
v_mfma_f32_16x16x16_bf16 v[24:27], v[32:33], v[130:131], v[24:27]
v_and_b32 v34, v65, v4
v_and_b32 v35, v65, v5
s_waitcnt vmcnt(10)
s_cmp_ge_u32 s27, 34
s_cbranch_scc1 L_w121
s_waitcnt vmcnt(5)
L_w121:
buffer_load_dwordx4 v[128:131], v3, s[36:39], s70 offen offset:1024 nt
v_mfma_f32_16x16x16_bf16 v[20:23], v[34:35], v[132:133], v[20:23]
v_mfma_f32_16x16x16_bf16 v[24:27], v[34:35], v[134:135], v[24:27]
v_and_b32 v32, v66, v4
v_and_b32 v33, v66, v5
s_cmp_ge_u32 s27, 34
s_cbranch_scc1 L_e9
s_add_u32 s30, s24, 9
v_subrev_u32 v189, s30, v190
v_cmp_gt_u32 vcc, 64, v189
s_nop 0
s_bcnt1_i32_b32 s27, vcc_lo
s_and_b32 s99, vcc_hi, 0xff
s_bcnt1_i32_b32 s99, s99
s_mul_i32 s99, s99, 3
s_add_u32 s27, s27, s99
L_e9:
s_waitcnt vmcnt(10)
s_cmp_ge_u32 s27, 34
s_cbranch_scc1 L_w122
s_waitcnt vmcnt(4)
L_w122:
buffer_load_dwordx4 v[132:135], v3, s[36:39], s70 offen offset:2048 nt
v_mfma_f32_16x16x16_bf16 v[20:23], v[32:33], v[136:137], v[20:23]
v_mfma_f32_16x16x16_bf16 v[24:27], v[32:33], v[138:139], v[24:27]
v_and_b32 v34, v67, v4
v_and_b32 v35, v67, v5
s_waitcnt vmcnt(10)
s_cmp_ge_u32 s27, 34
s_cbranch_scc1 L_w123
s_waitcnt vmcnt(4)
L_w123:
buffer_load_dwordx4 v[136:139], v3, s[36:39], s70 offen offset:3072 nt
v_mfma_f32_16x16x16_bf16 v[20:23], v[34:35], v[140:141], v[20:23]
v_mfma_f32_16x16x16_bf16 v[24:27], v[34:35], v[142:143], v[24:27]
v_and_b32 v32, v68, v4
v_and_b32 v33, v68, v5
s_barrier
s_waitcnt vmcnt(8)
s_cmp_ge_u32 s27, 34
s_cbranch_scc1 L_w124
s_waitcnt vmcnt(4)
L_w124:
s_xor_b32 s70, s68, 212992
buffer_load_dwordx4 v[140:143], v3, s[36:39], s70 offen offset:0 nt
v_mfma_f32_16x16x16_bf16 v[20:23], v[32:33], v[144:145], v[20:23]
v_mfma_f32_16x16x16_bf16 v[24:27], v[32:33], v[146:147], v[24:27]
v_and_b32 v34, v69, v4
v_and_b32 v35, v69, v5
s_add_u32 s30, s24, 9
v_subrev_u32 v189, s30, v190
v_cmp_gt_u32 vcc, 64, v189
s_nop 0
s_bcnt1_i32_b32 s27, vcc_lo
s_and_b32 s99, vcc_hi, 0xff
s_bcnt1_i32_b32 s99, s99
s_mul_i32 s99, s99, 3
s_add_u32 s27, s27, s99
s_waitcnt vmcnt(7)
s_cmp_ge_u32 s27, 34
s_cbranch_scc1 L_w125
s_waitcnt vmcnt(4)
L_w125:
buffer_load_dwordx4 v[144:147], v3, s[36:39], s70 offen offset:1024 nt
v_mfma_f32_16x16x16_bf16 v[20:23], v[34:35], v[148:149], v[20:23]
v_mfma_f32_16x16x16_bf16 v[24:27], v[34:35], v[150:151], v[24:27]
v_and_b32 v32, v70, v4
v_and_b32 v33, v70, v5
v_mov_b32 v36, 0
s_cmp_eq_u32 s76, 0
s_mov_b32 exec_hi, s8
s_mov_b32 exec_lo, 0
s_cbranch_scc0 L_gs1
buffer_store_dwordx4 v[120:123], v36, s[60:63], s21 offen
L_gr1:
s_mov_b64 exec, -1
s_waitcnt vmcnt(8)
s_cmp_ge_u32 s27, 34
s_cbranch_scc1 L_w126
s_waitcnt vmcnt(5)
L_w126:
buffer_load_dwordx4 v[148:151], v3, s[36:39], s70 offen offset:2048 nt
v_mfma_f32_16x16x16_bf16 v[20:23], v[32:33], v[152:153], v[20:23]
v_mfma_f32_16x16x16_bf16 v[24:27], v[32:33], v[154:155], v[24:27]
v_and_b32 v34, v71, v4
v_and_b32 v35, v71, v5
s_waitcnt vmcnt(8)
s_cmp_ge_u32 s27, 34
s_cbranch_scc1 L_w127
s_waitcnt vmcnt(5)
L_w127:
buffer_load_dwordx4 v[152:155], v3, s[36:39], s70 offen offset:3072 nt
v_mfma_f32_16x16x16_bf16 v[20:23], v[34:35], v[156:157], v[20:23]
v_mfma_f32_16x16x16_bf16 v[24:27], v[34:35], v[158:159], v[24:27]
v_and_b32 v32, v72, v4
v_and_b32 v33, v72, v5
s_add_u32 s30, s24, 10
v_mov_b32 v189, s30
s_mov_b32 exec_hi, 0xff
buffer_load_dword v190, v188, s[60:63], 0 offen nt
s_mov_b64 exec, 1
buffer_store_dword v189, v191, s[60:63], 0 offen
s_mov_b64 exec, -1
s_waitcnt vmcnt(10)
s_cmp_ge_u32 s27, 34
s_cbranch_scc1 L_w128
s_waitcnt vmcnt(7)
L_w128:
s_xor_b32 s70, s68, 262144
buffer_load_dwordx4 v[156:159], v3, s[36:39], s70 offen offset:0 nt
v_mfma_f32_16x16x16_bf16 v[20:23], v[32:33], v[160:161], v[20:23]
v_mfma_f32_16x16x16_bf16 v[24:27], v[32:33], v[162:163], v[24:27]
v_and_b32 v34, v73, v4
v_and_b32 v35, v73, v5
s_waitcnt vmcnt(10)
s_cmp_ge_u32 s27, 34
s_cbranch_scc1 L_w129
s_waitcnt vmcnt(7)
L_w129:
buffer_load_dwordx4 v[160:163], v3, s[36:39], s70 offen offset:1024 nt
v_mfma_f32_16x16x16_bf16 v[20:23], v[34:35], v[128:129], v[20:23]
v_mfma_f32_16x16x16_bf16 v[24:27], v[34:35], v[130:131], v[24:27]
v_and_b32 v32, v74, v4
v_and_b32 v33, v74, v5
s_waitcnt vmcnt(10)
s_cmp_ge_u32 s27, 34
s_cbranch_scc1 L_w130
s_waitcnt vmcnt(7)
L_w130:
buffer_load_dwordx4 v[128:131], v3, s[36:39], s70 offen offset:2048 nt
v_mfma_f32_16x16x16_bf16 v[20:23], v[32:33], v[132:133], v[20:23]
v_mfma_f32_16x16x16_bf16 v[24:27], v[32:33], v[134:135], v[24:27]
v_and_b32 v34, v75, v4
v_and_b32 v35, v75, v5
s_waitcnt vmcnt(10)
s_cmp_ge_u32 s27, 34
s_cbranch_scc1 L_w131
s_waitcnt vmcnt(6)
L_w131:
buffer_load_dwordx4 v[132:135], v3, s[36:39], s70 offen offset:3072 nt
v_mfma_f32_16x16x16_bf16 v[20:23], v[34:35], v[136:137], v[20:23]
v_mfma_f32_16x16x16_bf16 v[24:27], v[34:35], v[138:139], v[24:27]
v_and_b32 v32, v76, v4
v_and_b32 v33, v76, v5
s_barrier
s_waitcnt vmcnt(10)
s_cmp_ge_u32 s27, 34
s_cbranch_scc1 L_w132
s_waitcnt vmcnt(6)
L_w132:
s_xor_b32 s70, s68, 278528
buffer_load_dwordx4 v[136:139], v3, s[36:39], s70 offen offset:0 nt
v_mfma_f32_16x16x16_bf16 v[20:23], v[32:33], v[140:141], v[20:23]
v_mfma_f32_16x16x16_bf16 v[24:27], v[32:33], v[142:143], v[24:27]
v_and_b32 v34, v77, v4
v_and_b32 v35, v77, v5
s_waitcnt vmcnt(10)
s_cmp_ge_u32 s27, 34
s_cbranch_scc1 L_w133
s_waitcnt vmcnt(4)
L_w133:
buffer_load_dwordx4 v[140:143], v3, s[36:39], s70 offen offset:1024 nt
v_mfma_f32_16x16x16_bf16 v[20:23], v[34:35], v[144:145], v[20:23]
v_mfma_f32_16x16x16_bf16 v[24:27], v[34:35], v[146:147], v[24:27]
v_and_b32 v32, v78, v4
v_and_b32 v33, v78, v5
s_cmp_ge_u32 s27, 34
s_cbranch_scc1 L_e10
s_add_u32 s30, s24, 10
v_subrev_u32 v189, s30, v190
v_cmp_gt_u32 vcc, 64, v189
s_nop 0
s_bcnt1_i32_b32 s27, vcc_lo
s_add_u32 s27, s27, 12
L_e10:
s_waitcnt vmcnt(9)
s_cmp_ge_u32 s27, 34
s_cbranch_scc1 L_w134
s_waitcnt vmcnt(4)
L_w134:
buffer_load_dwordx4 v[144:147], v3, s[36:39], s70 offen offset:2048 nt
v_mfma_f32_16x16x16_bf16 v[20:23], v[32:33], v[148:149], v[20:23]
v_mfma_f32_16x16x16_bf16 v[24:27], v[32:33], v[150:151], v[24:27]
v_and_b32 v34, v79, v4
v_and_b32 v35, v79, v5
s_waitcnt vmcnt(9)
s_cmp_ge_u32 s27, 34
s_cbranch_scc1 L_w135
s_waitcnt vmcnt(4)
L_w135:
buffer_load_dwordx4 v[148:151], v3, s[36:39], s70 offen offset:3072 nt
v_mfma_f32_16x16x16_bf16 v[20:23], v[34:35], v[152:153], v[20:23]
v_mfma_f32_16x16x16_bf16 v[24:27], v[34:35], v[154:155], v[24:27]
v_and_b32 v32, v80, v4
v_and_b32 v33, v80, v5
s_waitcnt vmcnt(7)
s_cmp_ge_u32 s27, 34
s_cbranch_scc1 L_w136
s_waitcnt vmcnt(4)
L_w136:
s_xor_b32 s70, s68, 327680
buffer_load_dwordx4 v[152:155], v3, s[36:39], s70 offen offset:0 nt
v_mfma_f32_16x16x16_bf16 v[20:23], v[32:33], v[156:157], v[20:23]
v_mfma_f32_16x16x16_bf16 v[24:27], v[32:33], v[158:159], v[24:27]
v_and_b32 v34, v81, v4
v_and_b32 v35, v81, v5
s_add_u32 s30, s24, 10
v_subrev_u32 v189, s30, v190
v_cmp_gt_u32 vcc, 64, v189
s_nop 0
s_bcnt1_i32_b32 s27, vcc_lo
s_add_u32 s27, s27, 12
s_waitcnt vmcnt(7)
s_cmp_ge_u32 s27, 34
s_cbranch_scc1 L_w137
s_waitcnt vmcnt(4)
L_w137:
buffer_load_dwordx4 v[156:159], v3, s[36:39], s70 offen offset:1024 nt
v_mfma_f32_16x16x16_bf16 v[20:23], v[34:35], v[160:161], v[20:23]
v_mfma_f32_16x16x16_bf16 v[24:27], v[34:35], v[162:163], v[24:27]
v_and_b32 v32, v82, v4
v_and_b32 v33, v82, v5
s_waitcnt vmcnt(7)
s_cmp_ge_u32 s27, 34
s_cbranch_scc1 L_w138
s_waitcnt vmcnt(4)
L_w138:
buffer_load_dwordx4 v[160:163], v3, s[36:39], s70 offen offset:2048 nt
v_mfma_f32_16x16x16_bf16 v[20:23], v[32:33], v[128:129], v[20:23]
v_mfma_f32_16x16x16_bf16 v[24:27], v[32:33], v[130:131], v[24:27]
v_and_b32 v34, v83, v4
v_and_b32 v35, v83, v5
s_waitcnt vmcnt(7)
s_cmp_ge_u32 s27, 34
s_cbranch_scc1 L_w139
s_waitcnt vmcnt(4)
L_w139:
buffer_load_dwordx4 v[128:131], v3, s[36:39], s70 offen offset:3072 nt
v_mfma_f32_16x16x16_bf16 v[20:23], v[34:35], v[132:133], v[20:23]
v_mfma_f32_16x16x16_bf16 v[24:27], v[34:35], v[134:135], v[24:27]
v_and_b32 v32, v84, v4
v_and_b32 v33, v84, v5
s_cmp_eq_u32 s76, 0
s_cbranch_scc0 L_gs2
buffer_load_dwordx4 v[240:243], v114, s[60:63], s11 offen offset:0 nt
buffer_load_dwordx4 v[244:247], v114, s[60:63], s11 offen offset:64 nt
L_gr2:
s_barrier
s_add_u32 s30, s24, 11
v_mov_b32 v189, s30
s_mov_b32 exec_hi, 0xff
buffer_load_dword v190, v188, s[60:63], 0 offen nt
s_mov_b64 exec, 1
buffer_store_dword v189, v191, s[60:63], 0 offen
s_mov_b64 exec, -1
s_waitcnt vmcnt(11)
s_cmp_ge_u32 s27, 34
s_cbranch_scc1 L_w140
s_waitcnt vmcnt(8)
L_w140:
s_xor_b32 s70, s68, 344064
buffer_load_dwordx4 v[132:135], v3, s[36:39], s70 offen offset:0 nt
v_mfma_f32_16x16x16_bf16 v[20:23], v[32:33], v[136:137], v[20:23]
v_mfma_f32_16x16x16_bf16 v[24:27], v[32:33], v[138:139], v[24:27]
v_and_b32 v34, v85, v4
v_and_b32 v35, v85, v5
s_waitcnt vmcnt(11)
s_cmp_ge_u32 s27, 34
s_cbranch_scc1 L_w141
s_waitcnt vmcnt(8)
L_w141:
buffer_load_dwordx4 v[136:139], v3, s[36:39], s70 offen offset:1024 nt
v_mfma_f32_16x16x16_bf16 v[20:23], v[34:35], v[140:141], v[20:23]
v_mfma_f32_16x16x16_bf16 v[24:27], v[34:35], v[142:143], v[24:27]
v_and_b32 v32, v86, v4
v_and_b32 v33, v86, v5
s_waitcnt vmcnt(11)
s_cmp_ge_u32 s27, 34
s_cbranch_scc1 L_w142
s_waitcnt vmcnt(8)
L_w142:
buffer_load_dwordx4 v[140:143], v3, s[36:39], s70 offen offset:2048 nt
v_mfma_f32_16x16x16_bf16 v[20:23], v[32:33], v[144:145], v[20:23]
v_mfma_f32_16x16x16_bf16 v[24:27], v[32:33], v[146:147], v[24:27]
v_and_b32 v34, v87, v4
v_and_b32 v35, v87, v5
s_waitcnt vmcnt(11)
s_cmp_ge_u32 s27, 34
s_cbranch_scc1 L_w143
s_waitcnt vmcnt(8)
L_w143:
buffer_load_dwordx4 v[144:147], v3, s[36:39], s70 offen offset:3072 nt
v_mfma_f32_16x16x16_bf16 v[20:23], v[34:35], v[148:149], v[20:23]
v_mfma_f32_16x16x16_bf16 v[24:27], v[34:35], v[150:151], v[24:27]
v_and_b32 v32, v88, v4
v_and_b32 v33, v88, v5
s_waitcnt vmcnt(11)
s_cmp_ge_u32 s27, 34
s_cbranch_scc1 L_w144
s_waitcnt vmcnt(8)
L_w144:
s_xor_b32 s70, s68, 393216
buffer_load_dwordx4 v[148:151], v3, s[36:39], s70 offen offset:0 nt
v_mfma_f32_16x16x16_bf16 v[20:23], v[32:33], v[152:153], v[20:23]
v_mfma_f32_16x16x16_bf16 v[24:27], v[32:33], v[154:155], v[24:27]
v_and_b32 v34, v89, v4
v_and_b32 v35, v89, v5
s_waitcnt vmcnt(11)
s_cmp_ge_u32 s27, 34
s_cbranch_scc1 L_w145
s_waitcnt vmcnt(4)
L_w145:
buffer_load_dwordx4 v[152:155], v3, s[36:39], s70 offen offset:1024 nt
v_mfma_f32_16x16x16_bf16 v[20:23], v[34:35], v[156:157], v[20:23]
v_mfma_f32_16x16x16_bf16 v[24:27], v[34:35], v[158:159], v[24:27]
v_and_b32 v32, v90, v4
v_and_b32 v33, v90, v5
s_cmp_ge_u32 s27, 34
s_cbranch_scc1 L_e11
s_add_u32 s30, s24, 11
v_subrev_u32 v189, s30, v190
v_cmp_gt_u32 vcc, 64, v189
s_nop 0
s_bcnt1_i32_b32 s27, vcc_lo
s_add_u32 s27, s27, 12
L_e11:
s_waitcnt vmcnt(11)
s_cmp_ge_u32 s27, 34
s_cbranch_scc1 L_w146
s_waitcnt vmcnt(4)
L_w146:
buffer_load_dwordx4 v[156:159], v3, s[36:39], s70 offen offset:2048 nt
v_mfma_f32_16x16x16_bf16 v[20:23], v[32:33], v[160:161], v[20:23]
v_mfma_f32_16x16x16_bf16 v[24:27], v[32:33], v[162:163], v[24:27]
v_and_b32 v34, v91, v4
v_and_b32 v35, v91, v5
s_waitcnt vmcnt(11)
s_cmp_ge_u32 s27, 34
s_cbranch_scc1 L_w147
s_waitcnt vmcnt(4)
L_w147:
buffer_load_dwordx4 v[160:163], v3, s[36:39], s70 offen offset:3072 nt
v_mfma_f32_16x16x16_bf16 v[20:23], v[34:35], v[128:129], v[20:23]
v_mfma_f32_16x16x16_bf16 v[24:27], v[34:35], v[130:131], v[24:27]
v_and_b32 v32, v92, v4
v_and_b32 v33, v92, v5
s_barrier
s_waitcnt vmcnt(7)
s_cmp_ge_u32 s27, 34
s_cbranch_scc1 L_w148
s_waitcnt vmcnt(4)
L_w148:
s_add_u32 m0, s75, 0
s_xor_b32 s30, s4, 0
buffer_load_dwordx4 v44, s[48:51], s30 offen nt lds
v_mfma_f32_16x16x16_bf16 v[20:23], v[32:33], v[132:133], v[20:23]
v_mfma_f32_16x16x16_bf16 v[24:27], v[32:33], v[134:135], v[24:27]
v_and_b32 v34, v93, v4
v_and_b32 v35, v93, v5
s_nop 5
L_chk_ml:
v_xor_b32 v240, v6, v240
v_xor_b32 v241, v7, v241
v_xor_b32 v242, v8, v242
v_xor_b32 v243, v9, v243
v_xor_b32 v244, v6, v244
v_xor_b32 v245, v7, v245
v_xor_b32 v246, v8, v246
v_xor_b32 v247, v9, v247
v_or3_b32 v43, v240, v241, v242
v_or3_b32 v43, v43, v243, v244
v_or3_b32 v43, v43, v245, v246
v_or_b32 v43, v43, v247
v_cmp_ne_u32_sdwa vcc, v43, v0 src0_sel:BYTE_0 src1_sel:BYTE_3
s_cbranch_vccnz L_rt_ml
s_add_u32 s30, s24, 11
v_subrev_u32 v189, s30, v190
v_cmp_gt_u32 vcc, 64, v189
s_nop 0
s_bcnt1_i32_b32 s27, vcc_lo
s_add_u32 s27, s27, 12
s_waitcnt vmcnt(7)
s_cmp_ge_u32 s27, 34
s_cbranch_scc1 L_w149
s_waitcnt vmcnt(4)
L_w149:
s_add_u32 m0, s75, 1024
s_xor_b32 s30, s4, 8192
buffer_load_dwordx4 v45, s[48:51], s30 offen nt lds
v_max_f32 v36, v242, v246
v_mov_b32 v37, v36
s_nop 1
v_permlane32_swap_b32 v36, v37
v_max_f32 v36, v36, v37
v_mov_b32 v37, v36
s_nop 1
v_permlane16_swap_b32 v36, v37
v_max_f32 v36, v36, v37
v_sub_f32 v242, v242, v36
v_sub_f32 v246, v246, v36
v_exp_f32 v242, v242
v_exp_f32 v246, v246
v_mul_f32 v36, v242, v243
v_fmac_f32 v36, v246, v247
v_mov_b32 v37, v36
s_nop 1
v_permlane32_swap_b32 v36, v37
v_add_f32 v36, v36, v37
v_mov_b32 v37, v36
s_nop 1
v_permlane16_swap_b32 v36, v37
v_add_f32 v36, v36, v37
v_rcp_f32 v36, v36
s_nop 0
v_mul_f32 v14, v242, v36
v_mul_f32 v15, v246, v36
s_waitcnt vmcnt(7)
s_cmp_ge_u32 s27, 34
s_cbranch_scc1 L_w150
s_waitcnt vmcnt(4)
L_w150:
s_add_u32 m0, s75, 2048
s_xor_b32 s30, s4, 16384
buffer_load_dwordx4 v44, s[48:51], s30 offen nt lds
v_max_f32 v36, v240, v244
v_mov_b32 v37, v36
s_nop 1
v_permlane32_swap_b32 v36, v37
v_max_f32 v36, v36, v37
v_mov_b32 v37, v36
s_nop 1
v_permlane16_swap_b32 v36, v37
v_max_f32 v36, v36, v37
v_sub_f32 v240, v240, v36
v_sub_f32 v244, v244, v36
v_exp_f32 v240, v240
v_exp_f32 v244, v244
v_mul_f32 v36, v240, v241
v_fmac_f32 v36, v244, v245
v_mov_b32 v37, v36
s_nop 1
v_permlane32_swap_b32 v36, v37
v_add_f32 v36, v36, v37
v_mov_b32 v37, v36
s_nop 1
v_permlane16_swap_b32 v36, v37
v_add_f32 v36, v36, v37
v_rcp_f32 v36, v36
s_nop 0
v_mul_f32 v12, v240, v36
v_mul_f32 v13, v244, v36
v_mfma_f32_16x16x16_bf16 v[20:23], v[34:35], v[136:137], v[20:23]
v_mfma_f32_16x16x16_bf16 v[24:27], v[34:35], v[138:139], v[24:27]
v_and_b32 v32, v94, v4
v_and_b32 v33, v94, v5
s_waitcnt vmcnt(7)
s_cmp_ge_u32 s27, 34
s_cbranch_scc1 L_w151
s_waitcnt vmcnt(4)
L_w151:
s_add_u32 m0, s75, 3072
s_xor_b32 s30, s4, 24576
buffer_load_dwordx4 v45, s[48:51], s30 offen nt lds
s_cmp_eq_u32 s76, 0
s_cbranch_scc0 L_gs3
buffer_load_dwordx4 v[240:243], v3, s[60:63], s5 offen offset:0 nt
buffer_load_dwordx4 v[244:247], v3, s[60:63], s5 offen offset:1024 nt
L_gr3:
v_mfma_f32_16x16x16_bf16 v[20:23], v[32:33], v[140:141], v[20:23]
v_mfma_f32_16x16x16_bf16 v[24:27], v[32:33], v[142:143], v[24:27]
v_and_b32 v34, v95, v4
v_and_b32 v35, v95, v5
s_nop 1
v_mfma_f32_16x16x16_bf16 v[20:23], v[34:35], v[144:145], v[20:23]
v_mfma_f32_16x16x16_bf16 v[24:27], v[34:35], v[146:147], v[24:27]
v_and_b32 v32, v96, v4
v_and_b32 v33, v96, v5
s_waitcnt vmcnt(9)
s_cmp_ge_u32 s27, 34
s_cbranch_scc1 L_w152
s_waitcnt vmcnt(7)
L_w152:
s_xor_b32 s70, s68, 409600
buffer_load_dwordx4 v[128:131], v3, s[36:39], s70 offen offset:0 nt
v_mfma_f32_16x16x16_bf16 v[20:23], v[32:33], v[148:149], v[20:23]
v_mfma_f32_16x16x16_bf16 v[24:27], v[32:33], v[150:151], v[24:27]
v_and_b32 v34, v97, v4
v_and_b32 v35, v97, v5
s_waitcnt vmcnt(9)
s_cmp_ge_u32 s27, 34
s_cbranch_scc1 L_w153
s_waitcnt vmcnt(7)
L_w153:
buffer_load_dwordx4 v[132:135], v3, s[36:39], s70 offen offset:1024 nt
v_mfma_f32_16x16x16_bf16 v[20:23], v[34:35], v[152:153], v[20:23]
v_mfma_f32_16x16x16_bf16 v[24:27], v[34:35], v[154:155], v[24:27]
v_and_b32 v32, v98, v4
v_and_b32 v33, v98, v5
s_waitcnt vmcnt(9)
s_cmp_ge_u32 s27, 34
s_cbranch_scc1 L_w154
s_waitcnt vmcnt(7)
L_w154:
buffer_load_dwordx4 v[136:139], v3, s[36:39], s70 offen offset:2048 nt
v_mfma_f32_16x16x16_bf16 v[20:23], v[32:33], v[156:157], v[20:23]
v_mfma_f32_16x16x16_bf16 v[24:27], v[32:33], v[158:159], v[24:27]
v_and_b32 v34, v99, v4
v_and_b32 v35, v99, v5
s_waitcnt vmcnt(9)
s_cmp_ge_u32 s27, 34
s_cbranch_scc1 L_w155
s_waitcnt vmcnt(7)
L_w155:
buffer_load_dwordx4 v[140:143], v3, s[36:39], s70 offen offset:3072 nt
v_mfma_f32_16x16x16_bf16 v[20:23], v[34:35], v[160:161], v[20:23]
v_mfma_f32_16x16x16_bf16 v[24:27], v[34:35], v[162:163], v[24:27]
v_and_b32 v32, v100, v4
v_and_b32 v33, v100, v5
s_barrier
s_waitcnt vmcnt(9)
s_cmp_ge_u32 s27, 34
s_cbranch_scc1 L_w156
s_waitcnt vmcnt(7)
L_w156:
s_xor_b32 s70, s68, 458752
buffer_load_dwordx4 v[144:147], v3, s[36:39], s70 offen offset:0 nt
s_waitcnt vmcnt(9)
s_cmp_ge_u32 s27, 34
s_cbranch_scc1 L_w157
s_waitcnt vmcnt(7)
L_w157:
buffer_load_dwordx4 v[148:151], v3, s[36:39], s70 offen offset:1024 nt
s_waitcnt vmcnt(9)
s_cmp_ge_u32 s27, 34
s_cbranch_scc1 L_w158
s_waitcnt vmcnt(5)
L_w158:
buffer_load_dwordx4 v[152:155], v3, s[36:39], s70 offen offset:2048 nt
s_waitcnt vmcnt(9)
s_cmp_ge_u32 s27, 34
s_cbranch_scc1 L_w159
s_waitcnt vmcnt(5)
L_w159:
buffer_load_dwordx4 v[156:159], v3, s[36:39], s70 offen offset:3072 nt
s_waitcnt vmcnt(7)
s_cmp_ge_u32 s27, 34
s_cbranch_scc1 L_w160
s_waitcnt vmcnt(5)
L_w160:
s_xor_b32 s70, s68, 475136
buffer_load_dwordx4 v[160:163], v3, s[36:39], s70 offen offset:0 nt
v_mfma_f32_16x16x16_bf16 v[20:23], v[32:33], v[128:129], v[20:23]
v_mfma_f32_16x16x16_bf16 v[24:27], v[32:33], v[130:131], v[24:27]
v_and_b32 v34, v101, v4
v_and_b32 v35, v101, v5
s_waitcnt vmcnt(7)
s_cmp_ge_u32 s27, 34
s_cbranch_scc1 L_w161
s_waitcnt vmcnt(5)
L_w161:
buffer_load_dwordx4 v[128:131], v3, s[36:39], s70 offen offset:1024 nt
v_mfma_f32_16x16x16_bf16 v[20:23], v[34:35], v[132:133], v[20:23]
v_mfma_f32_16x16x16_bf16 v[24:27], v[34:35], v[134:135], v[24:27]
v_and_b32 v32, v102, v4
v_and_b32 v33, v102, v5
s_waitcnt vmcnt(7)
s_cmp_ge_u32 s27, 34
s_cbranch_scc1 L_w162
s_waitcnt vmcnt(5)
L_w162:
buffer_load_dwordx4 v[132:135], v3, s[36:39], s70 offen offset:2048 nt
v_mfma_f32_16x16x16_bf16 v[20:23], v[32:33], v[136:137], v[20:23]
v_mfma_f32_16x16x16_bf16 v[24:27], v[32:33], v[138:139], v[24:27]
v_and_b32 v34, v103, v4
v_and_b32 v35, v103, v5
v_lshlrev_b32 v224, 16, v240
v_and_b32 v225, s9, v240
v_lshlrev_b32 v226, 16, v241
v_and_b32 v227, s9, v241
v_lshlrev_b32 v228, 16, v242
v_and_b32 v229, s9, v242
v_lshlrev_b32 v230, 16, v243
v_and_b32 v231, s9, v243
v_pk_mul_f32 v[224:225], v[224:225], v[14:15] op_sel_hi:[1,0]
v_pk_mul_f32 v[226:227], v[226:227], v[14:15] op_sel_hi:[1,0]
v_pk_mul_f32 v[228:229], v[228:229], v[14:15] op_sel_hi:[1,0]
v_pk_mul_f32 v[230:231], v[230:231], v[14:15] op_sel_hi:[1,0]
v_lshlrev_b32 v232, 16, v244
v_and_b32 v233, s9, v244
v_lshlrev_b32 v234, 16, v245
v_and_b32 v235, s9, v245
v_lshlrev_b32 v236, 16, v246
v_and_b32 v237, s9, v246
v_lshlrev_b32 v238, 16, v247
v_and_b32 v239, s9, v247
s_waitcnt vmcnt(7)
s_cmp_ge_u32 s27, 34
s_cbranch_scc1 L_w163
s_waitcnt vmcnt(5)
L_w163:
buffer_load_dwordx4 v[136:139], v3, s[36:39], s70 offen offset:3072 nt
v_pk_fma_f32 v[224:225], v[232:233], v[14:15], v[224:225] op_sel:[0,1,0] op_sel_hi:[1,1,1]
v_pk_fma_f32 v[228:229], v[236:237], v[14:15], v[228:229] op_sel:[0,1,0] op_sel_hi:[1,1,1]
v_pk_fma_f32 v[226:227], v[234:235], v[14:15], v[226:227] op_sel:[0,1,0] op_sel_hi:[1,1,1]
v_pk_fma_f32 v[230:231], v[238:239], v[14:15], v[230:231] op_sel:[0,1,0] op_sel_hi:[1,1,1]
v_permlane32_swap_b32 v224, v228
v_permlane32_swap_b32 v225, v229
v_permlane32_swap_b32 v226, v230
v_permlane32_swap_b32 v227, v231
v_pk_add_f32 v[224:225], v[224:225], v[228:229]
v_pk_add_f32 v[226:227], v[226:227], v[230:231]
s_nop 1
v_permlane16_swap_b32 v224, v226
v_permlane16_swap_b32 v225, v227
v_pk_add_f32 v[224:225], v[224:225], v[226:227]
v_cvt_pk_bf16_f32 v224, v224, v225
ds_write_b32 v115, v224 offset:48640
s_waitcnt vmcnt(7)
s_cmp_ge_u32 s27, 34
s_cbranch_scc1 L_w164
s_waitcnt vmcnt(5)
L_w164:
s_add_u32 m0, s75, 16384
s_xor_b32 s30, s4, 0
buffer_load_dwordx4 v44, s[56:59], s30 offen nt lds
s_waitcnt lgkmcnt(0)
s_barrier
ds_read_b64_tr_b16 v[208:209], v46 offset:0
ds_read_b64_tr_b16 v[210:211], v46 offset:512
ds_read_b64_tr_b16 v[212:213], v46 offset:4096
ds_read_b64_tr_b16 v[214:215], v46 offset:4608
ds_read_b64_tr_b16 v[216:217], v46 offset:8192
ds_read_b64_tr_b16 v[218:219], v46 offset:8704
ds_read_b64_tr_b16 v[220:221], v46 offset:12288
ds_read_b64_tr_b16 v[222:223], v46 offset:12800
s_waitcnt vmcnt(7)
s_cmp_ge_u32 s27, 34
s_cbranch_scc1 L_w165
s_waitcnt vmcnt(5)
L_w165:
s_add_u32 m0, s75, 17408
s_xor_b32 s30, s4, 8192
buffer_load_dwordx4 v45, s[56:59], s30 offen nt lds
s_waitcnt lgkmcnt(0)
ds_read_b128 v[240:243], v116 offset:48640
ds_read_b128 v[244:247], v116 offset:48704
ds_read_b128 v[248:251], v116 offset:48768
ds_read_b128 v[252:255], v116 offset:48832
s_waitcnt lgkmcnt(3)
v_mfma_f32_16x16x32_bf16 v[224:227], v[208:211], v[240:243], 0
s_waitcnt lgkmcnt(2)
v_mfma_f32_16x16x32_bf16 v[224:227], v[212:215], v[244:247], v[224:227]
s_waitcnt lgkmcnt(1)
v_mfma_f32_16x16x32_bf16 v[224:227], v[216:219], v[248:251], v[224:227]
s_waitcnt lgkmcnt(0)
v_mfma_f32_16x16x32_bf16 v[224:227], v[220:223], v[252:255], v[224:227]
s_nop 7
v_and_or_b32 v124, v224, s72, v6
v_and_or_b32 v125, v225, s72, v7
v_and_or_b32 v126, v226, s72, v8
v_and_or_b32 v127, v227, s72, v9
s_waitcnt vmcnt(7)
s_cmp_ge_u32 s27, 34
s_cbranch_scc1 L_w166
s_waitcnt vmcnt(5)
L_w166:
s_add_u32 m0, s75, 18432
s_xor_b32 s30, s4, 16384
buffer_load_dwordx4 v44, s[56:59], s30 offen nt lds
v_mfma_f32_16x16x16_bf16 v[20:23], v[34:35], v[140:141], v[20:23]
v_mfma_f32_16x16x16_bf16 v[24:27], v[34:35], v[142:143], v[24:27]
v_and_b32 v32, v104, v4
v_and_b32 v33, v104, v5
s_nop 1
v_mfma_f32_16x16x16_bf16 v[20:23], v[32:33], v[144:145], v[20:23]
v_mfma_f32_16x16x16_bf16 v[24:27], v[32:33], v[146:147], v[24:27]
v_and_b32 v34, v105, v4
v_and_b32 v35, v105, v5
s_nop 1
v_mfma_f32_16x16x16_bf16 v[20:23], v[34:35], v[148:149], v[20:23]
v_mfma_f32_16x16x16_bf16 v[24:27], v[34:35], v[150:151], v[24:27]
v_and_b32 v32, v106, v4
v_and_b32 v33, v106, v5
s_nop 1
v_mfma_f32_16x16x16_bf16 v[20:23], v[32:33], v[152:153], v[20:23]
v_mfma_f32_16x16x16_bf16 v[24:27], v[32:33], v[154:155], v[24:27]
v_and_b32 v34, v107, v4
v_and_b32 v35, v107, v5
s_waitcnt vmcnt(7)
s_cmp_ge_u32 s27, 34
s_cbranch_scc1 L_w167
s_waitcnt vmcnt(5)
L_w167:
s_add_u32 m0, s75, 19456
s_xor_b32 s30, s4, 24576
buffer_load_dwordx4 v45, s[56:59], s30 offen nt lds
v_mfma_f32_16x16x16_bf16 v[20:23], v[34:35], v[156:157], v[20:23]
v_mfma_f32_16x16x16_bf16 v[24:27], v[34:35], v[158:159], v[24:27]
v_and_b32 v32, v108, v4
v_and_b32 v33, v108, v5
s_mov_b32 s14, 3
s_waitcnt vmcnt(7)
v_mfma_f32_16x16x16_bf16 v[20:23], v[32:33], v[160:161], v[20:23]
v_mfma_f32_16x16x16_bf16 v[24:27], v[32:33], v[162:163], v[24:27]
v_and_b32 v34, v109, v4
v_and_b32 v35, v109, v5
s_waitcnt vmcnt(6)
s_nop 0
v_mfma_f32_16x16x16_bf16 v[20:23], v[34:35], v[128:129], v[20:23]
v_mfma_f32_16x16x16_bf16 v[24:27], v[34:35], v[130:131], v[24:27]
v_and_b32 v32, v110, v4
v_and_b32 v33, v110, v5
s_waitcnt vmcnt(5)
s_nop 0
v_mfma_f32_16x16x16_bf16 v[20:23], v[32:33], v[132:133], v[20:23]
v_mfma_f32_16x16x16_bf16 v[24:27], v[32:33], v[134:135], v[24:27]
v_and_b32 v34, v111, v4
v_and_b32 v35, v111, v5
s_waitcnt vmcnt(4)
s_nop 0
v_mfma_f32_16x16x16_bf16 v[20:23], v[34:35], v[136:137], v[20:23]
v_mfma_f32_16x16x16_bf16 v[24:27], v[34:35], v[138:139], v[24:27]
buffer_store_dwordx4 v[124:127], v117, s[60:63], s6 offen sc1
s_nop 5
ds_write_b128 v40, v[20:23] offset:39936
ds_write_b128 v40, v[24:27] offset:39952
s_mov_b32 exec_hi, 0
s_cmp_eq_u32 s76, 0
s_waitcnt lgkmcnt(0)
s_barrier
ds_read_b128 v[20:23], v41 offset:39936
ds_read_b128 v[24:27], v41 offset:42112
ds_read_b128 v[32:35], v41 offset:44288
ds_read_b128 v[36:39], v41 offset:46464
s_waitcnt lgkmcnt(2)
v_pk_add_f32 v[20:21], v[20:21], v[24:25]
v_pk_add_f32 v[22:23], v[22:23], v[26:27]
s_waitcnt lgkmcnt(1)
v_pk_add_f32 v[20:21], v[20:21], v[32:33]
v_pk_add_f32 v[22:23], v[22:23], v[34:35]
s_waitcnt lgkmcnt(0)
v_pk_add_f32 v[20:21], v[20:21], v[36:37]
v_pk_add_f32 v[22:23], v[22:23], v[38:39]
v_cvt_pk_bf16_f32 v24, v20, v21
v_cvt_pk_bf16_f32 v25, v22, v23
s_cbranch_scc0 L_gs4
buffer_store_dwordx2 v[24:25], v42, s[60:63], s7 offen
s_mov_b32 exec_hi, -1
buffer_load_dwordx4 v[240:243], v3, s[60:63], s10 offen offset:0 nt
buffer_load_dwordx4 v[244:247], v3, s[60:63], s10 offen offset:1024 nt
L_gr4:
s_waitcnt vmcnt(4)
s_barrier
ds_read_b64_tr_b16 v[208:209], v46 offset:16384
ds_read_b64_tr_b16 v[210:211], v46 offset:16896
ds_read_b64_tr_b16 v[212:213], v46 offset:20480
ds_read_b64_tr_b16 v[214:215], v46 offset:20992
ds_read_b64_tr_b16 v[216:217], v46 offset:24576
ds_read_b64_tr_b16 v[218:219], v46 offset:25088
ds_read_b64_tr_b16 v[220:221], v46 offset:28672
ds_read_b64_tr_b16 v[222:223], v46 offset:29184
s_waitcnt vmcnt(1)
v_max3_u32 v43, v240, v241, v242
v_max_u32 v43, v43, v243
v_cmp_eq_u32 vcc, s20, v43
s_cbranch_vccnz L_h0s0
v_lshlrev_b32 v224, 16, v240
v_and_b32 v225, s9, v240
v_lshlrev_b32 v226, 16, v241
v_and_b32 v227, s9, v241
v_lshlrev_b32 v228, 16, v242
v_and_b32 v229, s9, v242
v_lshlrev_b32 v230, 16, v243
v_and_b32 v231, s9, v243
v_pk_mul_f32 v[224:225], v[224:225], v[12:13] op_sel_hi:[1,0]
v_pk_mul_f32 v[226:227], v[226:227], v[12:13] op_sel_hi:[1,0]
v_pk_mul_f32 v[228:229], v[228:229], v[12:13] op_sel_hi:[1,0]
v_pk_mul_f32 v[230:231], v[230:231], v[12:13] op_sel_hi:[1,0]
s_bitset0_b32 s14, 0
L_h0s0:
s_waitcnt vmcnt(0)
v_max3_u32 v43, v244, v245, v246
v_max_u32 v43, v43, v247
v_cmp_eq_u32 vcc, s20, v43
s_cbranch_vccnz L_h0s1
v_lshlrev_b32 v232, 16, v244
v_and_b32 v233, s9, v244
v_lshlrev_b32 v234, 16, v245
v_and_b32 v235, s9, v245
v_lshlrev_b32 v236, 16, v246
v_and_b32 v237, s9, v246
v_lshlrev_b32 v238, 16, v247
v_and_b32 v239, s9, v247
s_bitset0_b32 s14, 1
L_h0s1:
s_cmp_lg_u32 s14, 0
s_cbranch_scc1 L_h1a
L_h1d:
v_pk_fma_f32 v[224:225], v[232:233], v[12:13], v[224:225] op_sel:[0,1,0] op_sel_hi:[1,1,1]
v_pk_fma_f32 v[228:229], v[236:237], v[12:13], v[228:229] op_sel:[0,1,0] op_sel_hi:[1,1,1]
v_pk_fma_f32 v[226:227], v[234:235], v[12:13], v[226:227] op_sel:[0,1,0] op_sel_hi:[1,1,1]
v_pk_fma_f32 v[230:231], v[238:239], v[12:13], v[230:231] op_sel:[0,1,0] op_sel_hi:[1,1,1]
v_permlane32_swap_b32 v224, v228
v_permlane32_swap_b32 v225, v229
v_permlane32_swap_b32 v226, v230
v_permlane32_swap_b32 v227, v231
v_pk_add_f32 v[224:225], v[224:225], v[228:229]
v_pk_add_f32 v[226:227], v[226:227], v[230:231]
s_nop 1
v_permlane16_swap_b32 v224, v226
v_permlane16_swap_b32 v225, v227
v_pk_add_f32 v[224:225], v[224:225], v[226:227]
v_cvt_pk_bf16_f32 v224, v224, v225
ds_write_b32 v115, v224 offset:48640
s_waitcnt lgkmcnt(0)
s_barrier
ds_read_b128 v[240:243], v116 offset:48640
ds_read_b128 v[244:247], v116 offset:48704
ds_read_b128 v[248:251], v116 offset:48768
ds_read_b128 v[252:255], v116 offset:48832
s_waitcnt lgkmcnt(3)
v_mfma_f32_16x16x32_bf16 v[224:227], v[208:211], v[240:243], 0
s_waitcnt lgkmcnt(2)
v_mfma_f32_16x16x32_bf16 v[224:227], v[212:215], v[244:247], v[224:227]
s_waitcnt lgkmcnt(1)
v_mfma_f32_16x16x32_bf16 v[224:227], v[216:219], v[248:251], v[224:227]
s_waitcnt lgkmcnt(0)
v_mfma_f32_16x16x32_bf16 v[224:227], v[220:223], v[252:255], v[224:227]
s_cmp_lt_u32 s3, 2
s_nop 6
v_and_or_b32 v224, v224, s72, v6
v_and_or_b32 v225, v225, s72, v7
v_and_or_b32 v226, v226, s72, v8
v_and_or_b32 v227, v227, s72, v9
buffer_store_dwordx4 v[224:227], v117, s[60:63], s12 offen sc1
buffer_load_dwordx4 v[128:131], v112, s[60:63], s17 offen sc1
s_waitcnt vmcnt(0)
s_barrier
s_cbranch_scc1 L_end
s_cmp_eq_u32 s3, 3
s_cbranch_scc1 L_h2c
buffer_load_dwordx4 v[128:131], v112, s[60:63], s13 offen sc1
L_h2c:
s_waitcnt vmcnt(0)
v_xor_b32 v232, v6, v128
v_xor_b32 v233, v7, v129
v_xor_b32 v234, v8, v130
v_xor_b32 v235, v9, v131
v_or3_b32 v43, v232, v233, v234
v_or_b32 v43, v43, v235
v_cmp_ne_u32_sdwa vcc, v43, v0 src0_sel:BYTE_0 src1_sel:BYTE_3
s_cbranch_vccnz L_h2p
s_mov_b64 exec, -1
v_permlane32_swap_b32 v232, v234
v_permlane32_swap_b32 v233, v235
v_pk_add_f32 v[232:233], v[232:233], v[234:235]
s_nop 1
v_permlane16_swap_b32 v232, v233
v_add_f32 v232, v232, v233
s_nop 1
v_add_f32_dpp v232, v232, v232 row_ror:2 row_mask:0xf bank_mask:0xf
s_nop 1
v_add_f32_dpp v232, v232, v232 row_ror:4 row_mask:0xf bank_mask:0xf
s_nop 1
v_add_f32_dpp v232, v232, v232 row_ror:8 row_mask:0xf bank_mask:0xf
v_cvt_pk_bf16_f32 v232, v232, v232
buffer_store_short v232, v113, s[64:67], s15 offen
s_cmp_lg_u32 s3, 3
s_cbranch_scc1 L_end
s_cmp_lg_u32 s2, 0
s_cbranch_scc1 L_end
v_mov_b32 v233, s73
v_mov_b32 v235, 0
s_mov_b64 exec, 1
buffer_store_dword v233, v235, s[60:63], 0 offen sc1
L_end:
s_endpgm
L_h2p:
s_or_b64 exec, vcc, 0xffff
s_sub_u32 s74, s74, 1
s_cbranch_scc1 L_end
buffer_load_dwordx4 v[128:131], v112, s[60:63], s13 offen sc1
s_branch L_h2c
L_h1a:
s_sub_u32 s74, s74, 1
s_cbranch_scc1 L_end
s_bitcmp1_b32 s14, 0
s_cbranch_scc0 L_h1i0
buffer_load_dwordx4 v[240:243], v3, s[60:63], s10 offen offset:0 sc1
L_h1i0:
s_bitcmp1_b32 s14, 1
s_cbranch_scc0 L_h1i1
buffer_load_dwordx4 v[244:247], v3, s[60:63], s10 offen offset:1024 sc1
L_h1i1:
L_h1w:
s_waitcnt vmcnt(0)
s_bitcmp1_b32 s14, 0
s_cbranch_scc0 L_h1s0
v_max3_u32 v43, v240, v241, v242
v_max_u32 v43, v43, v243
v_cmp_eq_u32 vcc, s20, v43
s_cbranch_vccnz L_h1s0
v_lshlrev_b32 v224, 16, v240
v_and_b32 v225, s9, v240
v_lshlrev_b32 v226, 16, v241
v_and_b32 v227, s9, v241
v_lshlrev_b32 v228, 16, v242
v_and_b32 v229, s9, v242
v_lshlrev_b32 v230, 16, v243
v_and_b32 v231, s9, v243
v_pk_mul_f32 v[224:225], v[224:225], v[12:13] op_sel_hi:[1,0]
v_pk_mul_f32 v[226:227], v[226:227], v[12:13] op_sel_hi:[1,0]
v_pk_mul_f32 v[228:229], v[228:229], v[12:13] op_sel_hi:[1,0]
v_pk_mul_f32 v[230:231], v[230:231], v[12:13] op_sel_hi:[1,0]
s_bitset0_b32 s14, 0
L_h1s0:
s_bitcmp1_b32 s14, 1
s_cbranch_scc0 L_h1s1
v_max3_u32 v43, v244, v245, v246
v_max_u32 v43, v43, v247
v_cmp_eq_u32 vcc, s20, v43
s_cbranch_vccnz L_h1s1
v_lshlrev_b32 v232, 16, v244
v_and_b32 v233, s9, v244
v_lshlrev_b32 v234, 16, v245
v_and_b32 v235, s9, v245
v_lshlrev_b32 v236, 16, v246
v_and_b32 v237, s9, v246
v_lshlrev_b32 v238, 16, v247
v_and_b32 v239, s9, v247
s_bitset0_b32 s14, 1
L_h1s1:
s_cmp_lg_u32 s14, 0
s_cbranch_scc1 L_h1a
s_branch L_h1d
L_x_q:
v_and_b32 v36, 0x1f, v43
v_cmp_ne_u32 vcc, 0, v36
s_cbranch_vccnz L_rt_q
v_and_b32 v48, s72, v48
v_and_b32 v49, s72, v49
v_and_b32 v50, s72, v50
v_and_b32 v51, s72, v51
v_and_b32 v52, s72, v52
v_and_b32 v53, s72, v53
v_and_b32 v54, s72, v54
v_and_b32 v55, s72, v55
s_mov_b32 s76, 1
s_branch L_ok_q
L_rt_q:
s_sub_u32 s74, s74, 1
s_cbranch_scc1 L_end
buffer_load_dwordx4 v[48:51], v3, s[60:63], s5 offen sc1
buffer_load_dwordx4 v[52:55], v3, s[60:63], s5 offen offset:1024 sc1
s_waitcnt vmcnt(0)
s_branch L_chk_q
L_gs0:
buffer_store_dwordx2 v[38:39], v36, s[60:63], s7 offen sc1
s_branch L_gr0
L_gs1:
buffer_store_dwordx4 v[120:123], v36, s[60:63], s21 offen sc1
s_branch L_gr1
L_gs2:
buffer_load_dwordx4 v[240:243], v114, s[60:63], s11 offen offset:0 sc1
buffer_load_dwordx4 v[244:247], v114, s[60:63], s11 offen offset:64 sc1
s_branch L_gr2
L_rt_ml:
s_sub_u32 s74, s74, 1
s_cbranch_scc1 L_end
buffer_load_dwordx4 v[240:243], v114, s[60:63], s11 offen offset:0 sc1
buffer_load_dwordx4 v[244:247], v114, s[60:63], s11 offen offset:64 sc1
s_waitcnt vmcnt(0)
s_branch L_chk_ml
L_gs3:
buffer_load_dwordx4 v[240:243], v3, s[60:63], s5 offen offset:0 sc1
buffer_load_dwordx4 v[244:247], v3, s[60:63], s5 offen offset:1024 sc1
s_branch L_gr3
L_gs4:
buffer_store_dwordx2 v[24:25], v42, s[60:63], s7 offen sc1
s_mov_b32 exec_hi, -1
buffer_load_dwordx4 v[240:243], v3, s[60:63], s10 offen offset:0 sc1
buffer_load_dwordx4 v[244:247], v3, s[60:63], s10 offen offset:1024 sc1
s_branch L_gr4
L_code_end:
.section .rodata,"a"
.p2align 6
.amdhsa_kernel concat_heads__gqa_block_cached__sliding_block_cached__decode_kernel
  .amdhsa_next_free_vgpr 256
  .amdhsa_next_free_sgpr 102
  .amdhsa_accum_offset 256
  .amdhsa_group_segment_fixed_size 0
  .amdhsa_kernarg_size 104
  .amdhsa_user_sgpr_count 2
  .amdhsa_user_sgpr_kernarg_segment_ptr 1
  .amdhsa_system_sgpr_workgroup_id_x 1
  .amdhsa_float_denorm_mode_32 3
.end_amdhsa_kernel
```
